```python
import torch

def _softmax(x, axis=-1):
    return torch.softmax(x, dim=axis)
def _gelu(x):
    return torch.nn.functional.gelu(x, approximate="tanh")
def _silu(x):
    return torch.nn.functional.silu(x)
def _sigmoid(x):
    return torch.sigmoid(x)
def _layernorm(x, axis=-1, eps=1e-5):
    m = x.mean(dim=axis, keepdim=True)
    v = x.var(dim=axis, keepdim=True, unbiased=False)
    return (x - m) / torch.sqrt(v + eps)
def _scatter_add(tgt, idx, src, axis=0):
    return tgt.clone().index_add_(axis, idx, src)
def _segment_sum(src, seg, n):
    out = torch.zeros((n,) + src.shape[1:], dtype=src.dtype)
    return out.index_add_(0, seg, src)
def _pad(x, pw):
    flat = tuple(v for pair in reversed(pw) for v in pair)
    return torch.nn.functional.pad(x, flat)

kernel_name = 'gated_mix__gqa_block_cached__glu_gated_reglu__decode'

def setup_inputs():

    _w = (lambda a: (lambda t: t.to(torch.bfloat16) if t.is_floating_point() else t)(torch.as_tensor(a)))
    def _A_setup():
        B, Sq, D = 1, 1, 448
        Hq, Hkv, Sk, Dh = 16, 8, 65536, 256
        assert Hq % Hkv == 0, (Hq, Hkv)
        return {
            "x": _w((lambda *s: torch.randn(*s, dtype=torch.bfloat16) * 0.05)(B, Sq, D)),
            "k_cache": _w((lambda *s: torch.randn(*s, dtype=torch.bfloat16) * 6.4)(B, Hkv, Sk, Dh)),
            "v_cache": _w((lambda *s: torch.randn(*s, dtype=torch.bfloat16) * 0.05)(B, Hkv, Sk, Dh)),
            "wq": _w((lambda *s: torch.randn(*s, dtype=torch.bfloat16) * 6.4)(D, Hq * Dh) * (D ** -0.5)),
            "wo": _w((lambda *s: torch.randn(*s, dtype=torch.bfloat16) * 0.05)(Hq * Dh, D) * ((Hq * Dh) ** -0.5)),
        }
    _A_in = _A_setup()

    def _B_setup():
        B, S, D, F = 1, 1, 448, 1792
        return {
            "x": _w((lambda *s: torch.randn(*s, dtype=torch.bfloat16) * 0.05)(B, S, D)),
            "W_gate": _w((lambda *s: torch.randn(*s, dtype=torch.bfloat16) * 0.4)(D, F) * (2.0 / D) ** 0.5),
            "W_up": _w((lambda *s: torch.randn(*s, dtype=torch.bfloat16) * 0.4)(D, F) * (2.0 / D) ** 0.5),
            "W_down": _w((lambda *s: torch.randn(*s, dtype=torch.bfloat16) * 0.4)(F, D) * (1.0 / F) ** 0.5),
        }
    _B_in = _B_setup()

    return {
        "A_x": _A_in["x"],
        "A_k_cache": _A_in["k_cache"],
        "A_v_cache": _A_in["v_cache"],
        "A_wq": _A_in["wq"],
        "A_wo": _A_in["wo"],
        "B_x": _B_in["x"],
        "B_W_gate": _B_in["W_gate"],
        "B_W_up": _B_in["W_up"],
        "B_W_down": _B_in["W_down"],
        "gate_w": _w((lambda *s: torch.randn(*s, dtype=torch.bfloat16) * 0.05)(448) * 16.0),
    }

def reference(A_x, A_k_cache, A_v_cache, A_wq, A_wo, B_x, B_W_gate, B_W_up, B_W_down, gate_w):
    def _A_ref(x, k_cache, v_cache, wq, wo):
        B, Sq, D = x.shape
        Hq, Dh = 16, 256
        Hkv = k_cache.shape[1]
        rep = Hq // Hkv
        q = (lambda x, *d: x.permute(*d))((x @ wq).reshape(B, Sq, Hq, Dh), 0, 2, 1, 3)
        k = (lambda x, n, axis: torch.repeat_interleave(x, n, dim=axis))(k_cache, rep, axis=1)
        v = (lambda x, n, axis: torch.repeat_interleave(x, n, dim=axis))(v_cache, rep, axis=1)
        scores = torch.einsum("bhqd,bhkd->bhqk", q, k) * (Dh ** -0.5)
        p = _softmax(scores, axis=-1)
        o = torch.einsum("bhqk,bhkd->bhqd", p, v)
        return (lambda x, *d: x.permute(*d))(o, 0, 2, 1, 3).reshape(B, Sq, Hq * Dh) @ wo

    def _B_ref(x, W_gate, W_up, W_down):
        gate = torch.einsum("bsd,df->bsf", x, W_gate)
        up = torch.einsum("bsd,df->bsf", x, W_up)
        gate = gate * (lambda x, dt: x.to(dt))(gate > 0, gate.dtype)
        h = gate * up
        return torch.einsum("bsf,fd->bsd", h, W_down)

    x = A_x
    g = _sigmoid((x * gate_w).sum(-1, keepdims=True))
    a = _A_ref(x, A_k_cache, A_v_cache, A_wq, A_wo)
    b = _B_ref(x, B_W_gate, B_W_up, B_W_down)
    return g * a + (1 - g) * b
```

```asm
; @launch grid=(256,1,1) block=(384,1,1) lds=86016
.amdgcn_target "amdgcn-amd-amdhsa--gfx950"
.text
.globl gated_mix__gqa_block_cached__glu_gated_reglu__decode_kernel
.p2align 8
.type gated_mix__gqa_block_cached__glu_gated_reglu__decode_kernel,@function
gated_mix__gqa_block_cached__glu_gated_reglu__decode_kernel:
s_cmp_ge_u32 s2, 256
s_cbranch_scc1 L_done
s_load_dwordx4 s[12:15], s[0:1], 8
s_load_dwordx2 s[40:41], s[0:1], 96
v_lshrrev_b32 v2, 6, v0
v_and_b32 v1, 63, v0
s_and_b32 s5, s2, 31
v_readfirstlane_b32 s3, v2
s_lshr_b32 s4, s2, 5
s_and_b32 s6, s2, 7
v_lshrrev_b32 v2, 4, v1
v_and_b32 v3, 15, v1
s_cmp_lt_u32 s6, 2
s_cselect_b32 s9, 1, 0
s_cmp_lt_u32 s3, 2
s_cbranch_scc1 L_service
s_sub_u32 s8, s3, 2
s_lshr_b32 s43, s5, 4
s_mul_i32 s43, s43, 1792
s_and_b32 s54, s5, 15
s_lshl_b32 s63, s54, 2
s_add_u32 s63, s63, s43
s_add_u32 s63, s63, s8
s_lshl_b32 s60, s63, 13
s_lshl_b32 s42, s4, 25
v_lshlrev_b32 v8, 9, v3
v_lshl_add_u32 v8, v2, 4, v8
v_lshlrev_b32 v9, 11, v2
v_lshl_add_u32 v9, v3, 4, v9
s_mov_b32 s46, 0x2000000
s_mov_b32 s47, 0x20000
s_mov_b32 s50, 0x2000000
s_mov_b32 s51, 0x20000
s_cmp_eq_u32 s9, 0
s_cbranch_scc1 L_nob0_s
s_barrier
L_nob0_s:
s_waitcnt lgkmcnt(0)
s_add_u32 s44, s12, s42
s_addc_u32 s45, s13, 0
s_add_u32 s48, s14, s42
s_addc_u32 s49, s15, 0
buffer_load_dwordx4 v[64:67], v8, s[44:47], s60 offen offset:0 nt
buffer_load_dwordx4 v[68:71], v8, s[44:47], s60 offen offset:64 nt
buffer_load_dwordx4 v[72:75], v8, s[44:47], s60 offen offset:128 nt
buffer_load_dwordx4 v[76:79], v8, s[44:47], s60 offen offset:192 nt
buffer_load_dwordx4 v[80:83], v8, s[44:47], s60 offen offset:256 nt
buffer_load_dwordx4 v[84:87], v8, s[44:47], s60 offen offset:320 nt
buffer_load_dwordx4 v[88:91], v8, s[44:47], s60 offen offset:384 nt
buffer_load_dwordx4 v[92:95], v8, s[44:47], s60 offen offset:448 nt
buffer_load_dwordx4 v[96:99], v9, s[48:51], s60 offen offset:0 nt
buffer_load_dwordx4 v[100:103], v9, s[48:51], s60 offen offset:256 nt
buffer_load_dwordx4 v[104:107], v9, s[48:51], s60 offen offset:512 nt
buffer_load_dwordx4 v[108:111], v9, s[48:51], s60 offen offset:768 nt
buffer_load_dwordx4 v[112:115], v9, s[48:51], s60 offen offset:1024 nt
buffer_load_dwordx4 v[116:119], v9, s[48:51], s60 offen offset:1280 nt
buffer_load_dwordx4 v[120:123], v9, s[48:51], s60 offen offset:1536 nt
buffer_load_dwordx4 v[124:127], v9, s[48:51], s60 offen offset:1792 nt
s_cmp_lg_u32 s9, 0
s_cbranch_scc1 L_nob0n_s
s_barrier
L_nob0n_s:
v_and_b32 v10, 1, v1
v_lshlrev_b32 v10, 9, v10
v_lshl_add_u32 v10, v2, 4, v10
s_mul_i32 s63, s54, 2
s_add_u32 s63, s63, s43
s_add_u32 s63, s63, s8
s_add_u32 s63, s63, 160
s_lshr_b32 s61, s5, 3
s_and_b32 s61, s61, 1
s_mul_i32 s43, s4, 2
s_add_u32 s43, s43, s61
s_lshl_b32 s43, s43, 8
s_add_u32 s43, s43, 4096
s_add_u32 s52, s40, s43
s_addc_u32 s53, s41, 0
s_cmp_lt_u32 s8, 2
s_cselect_b32 s58, 50, 0
s_cselect_b32 s59, 1, 0
s_mov_b32 s65, 0x3db8aa3b
v_lshrrev_b32 v12, 2, v3
v_bfe_u32 v13, v3, 1, 1
v_mov_b32 v14, 0xffff
v_lshlrev_b32 v13, 4, v13
v_lshlrev_b32 v14, v13, v14
v_cmp_eq_u32 vcc, 0, v12
v_cmp_eq_u32 s[76:77], 1, v12
v_cmp_eq_u32 s[78:79], 2, v12
v_cmp_eq_u32 s[80:81], 3, v12
s_nop 1
v_cndmask_b32 v4, 0, v14, vcc
v_cndmask_b32 v5, 0, v14, s[76:77]
v_cndmask_b32 v6, 0, v14, s[78:79]
v_cndmask_b32 v7, 0, v14, s[80:81]
s_add_u32 s60, s60, 524288
s_waitcnt vmcnt(15)
buffer_load_dwordx4 v[128:131], v8, s[44:47], s60 offen offset:0 nt
s_waitcnt vmcnt(15)
buffer_load_dwordx4 v[132:135], v8, s[44:47], s60 offen offset:64 nt
s_waitcnt vmcnt(15)
buffer_load_dwordx4 v[136:139], v8, s[44:47], s60 offen offset:128 nt
s_waitcnt vmcnt(15)
buffer_load_dwordx4 v[140:143], v8, s[44:47], s60 offen offset:192 nt
s_waitcnt vmcnt(15)
buffer_load_dwordx4 v[144:147], v8, s[44:47], s60 offen offset:256 nt
s_waitcnt vmcnt(15)
buffer_load_dwordx4 v[148:151], v8, s[44:47], s60 offen offset:320 nt
s_waitcnt vmcnt(15)
buffer_load_dwordx4 v[152:155], v8, s[44:47], s60 offen offset:384 nt
s_waitcnt vmcnt(15)
buffer_load_dwordx4 v[156:159], v8, s[44:47], s60 offen offset:448 nt
s_waitcnt vmcnt(15)
buffer_load_dwordx4 v[160:163], v9, s[48:51], s60 offen offset:0 nt
s_waitcnt vmcnt(15)
buffer_load_dwordx4 v[164:167], v9, s[48:51], s60 offen offset:256 nt
s_waitcnt vmcnt(15)
buffer_load_dwordx4 v[168:171], v9, s[48:51], s60 offen offset:512 nt
s_waitcnt vmcnt(15)
buffer_load_dwordx4 v[172:175], v9, s[48:51], s60 offen offset:768 nt
s_waitcnt vmcnt(15)
buffer_load_dwordx4 v[176:179], v9, s[48:51], s60 offen offset:1024 nt
s_waitcnt vmcnt(15)
buffer_load_dwordx4 v[180:183], v9, s[48:51], s60 offen offset:1280 nt
s_waitcnt vmcnt(15)
buffer_load_dwordx4 v[184:187], v9, s[48:51], s60 offen offset:1536 nt
s_waitcnt vmcnt(15)
buffer_load_dwordx4 v[188:191], v9, s[48:51], s60 offen offset:1792 nt
s_add_u32 s60, s60, 524288
s_waitcnt vmcnt(15)
buffer_load_dwordx4 v[192:195], v8, s[44:47], s60 offen offset:0 nt
s_waitcnt vmcnt(15)
buffer_load_dwordx4 v[196:199], v8, s[44:47], s60 offen offset:64 nt
s_waitcnt vmcnt(15)
buffer_load_dwordx4 v[200:203], v8, s[44:47], s60 offen offset:128 nt
s_waitcnt vmcnt(15)
buffer_load_dwordx4 v[204:207], v8, s[44:47], s60 offen offset:192 nt
s_waitcnt vmcnt(15)
buffer_load_dwordx4 v[208:211], v8, s[44:47], s60 offen offset:256 nt
s_waitcnt vmcnt(15)
buffer_load_dwordx4 v[212:215], v8, s[44:47], s60 offen offset:320 nt
s_waitcnt vmcnt(15)
buffer_load_dwordx4 v[216:219], v8, s[44:47], s60 offen offset:384 nt
s_waitcnt vmcnt(15)
buffer_load_dwordx4 v[220:223], v8, s[44:47], s60 offen offset:448 nt
s_waitcnt vmcnt(15)
buffer_load_dwordx4 v[224:227], v9, s[48:51], s60 offen offset:0 nt
s_waitcnt vmcnt(15)
buffer_load_dwordx4 v[228:231], v9, s[48:51], s60 offen offset:256 nt
s_waitcnt vmcnt(15)
buffer_load_dwordx4 v[232:235], v9, s[48:51], s60 offen offset:512 nt
s_waitcnt vmcnt(15)
buffer_load_dwordx4 v[236:239], v9, s[48:51], s60 offen offset:768 nt
s_waitcnt vmcnt(15)
buffer_load_dwordx4 v[240:243], v9, s[48:51], s60 offen offset:1024 nt
s_waitcnt vmcnt(15)
buffer_load_dwordx4 v[244:247], v9, s[48:51], s60 offen offset:1280 nt
s_waitcnt vmcnt(15)
buffer_load_dwordx4 v[248:251], v9, s[48:51], s60 offen offset:1536 nt
s_waitcnt vmcnt(15)
buffer_load_dwordx4 v[252:255], v9, s[48:51], s60 offen offset:1792 nt
v_mov_b32 v0, 0xff7fffff
v_mov_b32 v1, 0
v_mov_b32 v2, 0
v_mov_b32 v24, 0
v_mov_b32 v25, 0
v_mov_b32 v26, 0
v_mov_b32 v27, 0
v_mov_b32 v28, 0
v_mov_b32 v29, 0
v_mov_b32 v30, 0
v_mov_b32 v31, 0
s_barrier
ds_read_b128 v[32:35], v10 offset:0
ds_read_b128 v[36:39], v10 offset:64
ds_read_b128 v[40:43], v10 offset:128
ds_read_b128 v[44:47], v10 offset:192
ds_read_b128 v[48:51], v10 offset:256
ds_read_b128 v[52:55], v10 offset:320
ds_read_b128 v[56:59], v10 offset:384
ds_read_b128 v[60:63], v10 offset:448
s_waitcnt lgkmcnt(0)
s_load_dword s55, s[52:53], 0 glc
s_cmp_lg_u32 s58, 0
s_cbranch_scc1 L_notk_p0
s_cmp_eq_u32 s59, 0
s_cbranch_scc1 L_notk_p0
s_mov_b32 s62, 1
s_atomic_add s62, s[52:53], 0 glc
L_notk_p0:
s_waitcnt vmcnt(40)
v_mfma_f32_16x16x32_bf16 v[12:15], v[64:67], v[32:35], 0
v_mfma_f32_16x16x32_bf16 v[12:15], v[68:71], v[36:39], v[12:15]
v_mfma_f32_16x16x32_bf16 v[12:15], v[72:75], v[40:43], v[12:15]
v_mfma_f32_16x16x32_bf16 v[12:15], v[76:79], v[44:47], v[12:15]
v_mfma_f32_16x16x32_bf16 v[12:15], v[80:83], v[48:51], v[12:15]
v_mfma_f32_16x16x32_bf16 v[12:15], v[84:87], v[52:55], v[12:15]
v_mfma_f32_16x16x32_bf16 v[12:15], v[88:91], v[56:59], v[12:15]
v_mfma_f32_16x16x32_bf16 v[12:15], v[92:95], v[60:63], v[12:15]
s_cmp_eq_u32 s58, 0
s_cbranch_scc1 L_dyn_p0
s_sub_u32 s58, s58, 1
s_add_u32 s63, s63, 32
s_mov_b32 s64, 1
s_branch L_nxt_p0
L_dyn_p0:
s_waitcnt lgkmcnt(0)
s_mul_i32 s63, s62, 2
s_add_u32 s63, s63, s61
s_add_u32 s63, s63, 3584
s_cmp_eq_u32 s59, 0
s_cselect_b32 s63, 4096, s63
s_cmp_lt_u32 s63, 4096
s_cselect_b32 s46, 0x2000000, 0
s_cselect_b32 s50, 0x2000000, 0
s_cselect_b32 s64, 1, 0
s_cselect_b32 s63, s63, 0
L_nxt_p0:
s_lshl_b32 s60, s63, 13
buffer_load_dwordx4 v[64:67], v8, s[44:47], s60 offen offset:0 nt
buffer_load_dwordx4 v[68:71], v8, s[44:47], s60 offen offset:64 nt
buffer_load_dwordx4 v[72:75], v8, s[44:47], s60 offen offset:128 nt
buffer_load_dwordx4 v[76:79], v8, s[44:47], s60 offen offset:192 nt
buffer_load_dwordx4 v[80:83], v8, s[44:47], s60 offen offset:256 nt
buffer_load_dwordx4 v[84:87], v8, s[44:47], s60 offen offset:320 nt
buffer_load_dwordx4 v[88:91], v8, s[44:47], s60 offen offset:384 nt
buffer_load_dwordx4 v[92:95], v8, s[44:47], s60 offen offset:448 nt
v_max3_f32 v10, v12, v13, v14
v_max_f32 v10, v10, v15
v_cmp_gt_f32 vcc, v10, v0
s_cbranch_vccz L_upd_ret_p0
v_max_f32 v10, v10, v0
v_mov_b32 v11, v10
s_nop 1
v_permlane16_swap_b32 v11, v10
s_nop 1
v_max_f32 v10, v10, v11
v_mov_b32 v11, v10
s_nop 1
v_permlane32_swap_b32 v11, v10
s_nop 1
v_max_f32 v10, v10, v11
v_sub_f32 v11, v0, v10
v_mul_f32 v11, s65, v11
v_exp_f32 v11, v11
v_mov_b32 v0, v10
v_mul_f32 v1, s65, v10
v_mul_f32 v2, v2, v11
s_nop 1
v_mul_f32_dpp v24, v11, v24 quad_perm:[0,0,0,0] row_mask:0xf bank_mask:0xf
v_mul_f32_dpp v25, v11, v25 quad_perm:[1,1,1,1] row_mask:0xf bank_mask:0xf
v_mul_f32_dpp v26, v11, v26 quad_perm:[0,0,0,0] row_mask:0xf bank_mask:0xf
v_mul_f32_dpp v27, v11, v27 quad_perm:[1,1,1,1] row_mask:0xf bank_mask:0xf
v_mul_f32_dpp v28, v11, v28 quad_perm:[0,0,0,0] row_mask:0xf bank_mask:0xf
v_mul_f32_dpp v29, v11, v29 quad_perm:[1,1,1,1] row_mask:0xf bank_mask:0xf
v_mul_f32_dpp v30, v11, v30 quad_perm:[0,0,0,0] row_mask:0xf bank_mask:0xf
v_mul_f32_dpp v31, v11, v31 quad_perm:[1,1,1,1] row_mask:0xf bank_mask:0xf
L_upd_ret_p0:
v_fma_f32 v12, v12, s65, -v1
v_fma_f32 v13, v13, s65, -v1
v_fma_f32 v14, v14, s65, -v1
v_fma_f32 v15, v15, s65, -v1
v_exp_f32 v12, v12
v_exp_f32 v13, v13
v_exp_f32 v14, v14
v_exp_f32 v15, v15
v_cvt_pk_bf16_f32 v10, v12, v12
v_add_f32 v11, v12, v13
v_add_f32 v3, v14, v15
v_and_b32 v16, v10, v4
v_and_b32 v17, v10, v5
v_and_b32 v18, v10, v6
v_and_b32 v19, v10, v7
v_cvt_pk_bf16_f32 v10, v13, v13
v_add_f32 v2, v2, v11
s_waitcnt vmcnt(40)
v_and_b32 v20, v10, v4
v_and_b32 v21, v10, v5
v_and_b32 v22, v10, v6
v_and_b32 v23, v10, v7
v_cvt_pk_bf16_f32 v10, v14, v14
v_add_f32 v2, v2, v3
v_mfma_f32_16x16x32_bf16 v[24:27], v[16:19], v[96:99], v[24:27]
v_mfma_f32_16x16x32_bf16 v[28:31], v[16:19], v[100:103], v[28:31]
v_and_b32 v16, v10, v4
v_and_b32 v17, v10, v5
v_and_b32 v18, v10, v6
v_and_b32 v19, v10, v7
v_cvt_pk_bf16_f32 v10, v15, v15
v_mfma_f32_16x16x32_bf16 v[24:27], v[20:23], v[104:107], v[24:27]
v_mfma_f32_16x16x32_bf16 v[28:31], v[20:23], v[108:111], v[28:31]
v_and_b32 v20, v10, v4
v_and_b32 v21, v10, v5
v_and_b32 v22, v10, v6
v_and_b32 v23, v10, v7
v_mfma_f32_16x16x32_bf16 v[24:27], v[16:19], v[112:115], v[24:27]
v_mfma_f32_16x16x32_bf16 v[28:31], v[16:19], v[116:119], v[28:31]
s_nop 0
v_mfma_f32_16x16x32_bf16 v[24:27], v[20:23], v[120:123], v[24:27]
v_mfma_f32_16x16x32_bf16 v[28:31], v[20:23], v[124:127], v[28:31]
buffer_load_dwordx4 v[96:99], v9, s[48:51], s60 offen offset:0 nt
buffer_load_dwordx4 v[100:103], v9, s[48:51], s60 offen offset:256 nt
buffer_load_dwordx4 v[104:107], v9, s[48:51], s60 offen offset:512 nt
buffer_load_dwordx4 v[108:111], v9, s[48:51], s60 offen offset:768 nt
buffer_load_dwordx4 v[112:115], v9, s[48:51], s60 offen offset:1024 nt
buffer_load_dwordx4 v[116:119], v9, s[48:51], s60 offen offset:1280 nt
buffer_load_dwordx4 v[120:123], v9, s[48:51], s60 offen offset:1536 nt
buffer_load_dwordx4 v[124:127], v9, s[48:51], s60 offen offset:1792 nt
s_waitcnt vmcnt(40)
v_mfma_f32_16x16x32_bf16 v[12:15], v[128:131], v[32:35], 0
v_mfma_f32_16x16x32_bf16 v[12:15], v[132:135], v[36:39], v[12:15]
v_mfma_f32_16x16x32_bf16 v[12:15], v[136:139], v[40:43], v[12:15]
v_mfma_f32_16x16x32_bf16 v[12:15], v[140:143], v[44:47], v[12:15]
v_mfma_f32_16x16x32_bf16 v[12:15], v[144:147], v[48:51], v[12:15]
v_mfma_f32_16x16x32_bf16 v[12:15], v[148:151], v[52:55], v[12:15]
v_mfma_f32_16x16x32_bf16 v[12:15], v[152:155], v[56:59], v[12:15]
v_mfma_f32_16x16x32_bf16 v[12:15], v[156:159], v[60:63], v[12:15]
s_nop 7
v_max3_f32 v10, v12, v13, v14
v_max_f32 v10, v10, v15
v_cmp_gt_f32 vcc, v10, v0
s_cbranch_vccz L_upd_ret_p1
v_max_f32 v10, v10, v0
v_mov_b32 v11, v10
s_nop 1
v_permlane16_swap_b32 v11, v10
s_nop 1
v_max_f32 v10, v10, v11
v_mov_b32 v11, v10
s_nop 1
v_permlane32_swap_b32 v11, v10
s_nop 1
v_max_f32 v10, v10, v11
v_sub_f32 v11, v0, v10
v_mul_f32 v11, s65, v11
v_exp_f32 v11, v11
v_mov_b32 v0, v10
v_mul_f32 v1, s65, v10
v_mul_f32 v2, v2, v11
s_nop 1
v_mul_f32_dpp v24, v11, v24 quad_perm:[0,0,0,0] row_mask:0xf bank_mask:0xf
v_mul_f32_dpp v25, v11, v25 quad_perm:[1,1,1,1] row_mask:0xf bank_mask:0xf
v_mul_f32_dpp v26, v11, v26 quad_perm:[0,0,0,0] row_mask:0xf bank_mask:0xf
v_mul_f32_dpp v27, v11, v27 quad_perm:[1,1,1,1] row_mask:0xf bank_mask:0xf
v_mul_f32_dpp v28, v11, v28 quad_perm:[0,0,0,0] row_mask:0xf bank_mask:0xf
v_mul_f32_dpp v29, v11, v29 quad_perm:[1,1,1,1] row_mask:0xf bank_mask:0xf
v_mul_f32_dpp v30, v11, v30 quad_perm:[0,0,0,0] row_mask:0xf bank_mask:0xf
v_mul_f32_dpp v31, v11, v31 quad_perm:[1,1,1,1] row_mask:0xf bank_mask:0xf
L_upd_ret_p1:
v_fma_f32 v12, v12, s65, -v1
v_fma_f32 v13, v13, s65, -v1
v_fma_f32 v14, v14, s65, -v1
v_fma_f32 v15, v15, s65, -v1
v_exp_f32 v12, v12
v_exp_f32 v13, v13
v_exp_f32 v14, v14
v_exp_f32 v15, v15
v_cvt_pk_bf16_f32 v10, v12, v12
v_add_f32 v11, v12, v13
v_add_f32 v3, v14, v15
v_and_b32 v16, v10, v4
v_and_b32 v17, v10, v5
v_and_b32 v18, v10, v6
v_and_b32 v19, v10, v7
v_cvt_pk_bf16_f32 v10, v13, v13
v_add_f32 v2, v2, v11
s_waitcnt vmcnt(32)
v_and_b32 v20, v10, v4
v_and_b32 v21, v10, v5
v_and_b32 v22, v10, v6
v_and_b32 v23, v10, v7
v_cvt_pk_bf16_f32 v10, v14, v14
v_add_f32 v2, v2, v3
v_mfma_f32_16x16x32_bf16 v[24:27], v[16:19], v[160:163], v[24:27]
v_mfma_f32_16x16x32_bf16 v[28:31], v[16:19], v[164:167], v[28:31]
v_and_b32 v16, v10, v4
v_and_b32 v17, v10, v5
v_and_b32 v18, v10, v6
v_and_b32 v19, v10, v7
v_cvt_pk_bf16_f32 v10, v15, v15
v_mfma_f32_16x16x32_bf16 v[24:27], v[20:23], v[168:171], v[24:27]
v_mfma_f32_16x16x32_bf16 v[28:31], v[20:23], v[172:175], v[28:31]
v_and_b32 v20, v10, v4
v_and_b32 v21, v10, v5
v_and_b32 v22, v10, v6
v_and_b32 v23, v10, v7
v_mfma_f32_16x16x32_bf16 v[24:27], v[16:19], v[176:179], v[24:27]
v_mfma_f32_16x16x32_bf16 v[28:31], v[16:19], v[180:183], v[28:31]
s_nop 0
v_mfma_f32_16x16x32_bf16 v[24:27], v[20:23], v[184:187], v[24:27]
v_mfma_f32_16x16x32_bf16 v[28:31], v[20:23], v[188:191], v[28:31]
s_waitcnt vmcnt(24)
v_mfma_f32_16x16x32_bf16 v[12:15], v[192:195], v[32:35], 0
v_mfma_f32_16x16x32_bf16 v[12:15], v[196:199], v[36:39], v[12:15]
v_mfma_f32_16x16x32_bf16 v[12:15], v[200:203], v[40:43], v[12:15]
v_mfma_f32_16x16x32_bf16 v[12:15], v[204:207], v[44:47], v[12:15]
v_mfma_f32_16x16x32_bf16 v[12:15], v[208:211], v[48:51], v[12:15]
v_mfma_f32_16x16x32_bf16 v[12:15], v[212:215], v[52:55], v[12:15]
v_mfma_f32_16x16x32_bf16 v[12:15], v[216:219], v[56:59], v[12:15]
v_mfma_f32_16x16x32_bf16 v[12:15], v[220:223], v[60:63], v[12:15]
s_nop 7
v_max3_f32 v10, v12, v13, v14
v_max_f32 v10, v10, v15
v_cmp_gt_f32 vcc, v10, v0
s_cbranch_vccz L_upd_ret_p2
v_max_f32 v10, v10, v0
v_mov_b32 v11, v10
s_nop 1
v_permlane16_swap_b32 v11, v10
s_nop 1
v_max_f32 v10, v10, v11
v_mov_b32 v11, v10
s_nop 1
v_permlane32_swap_b32 v11, v10
s_nop 1
v_max_f32 v10, v10, v11
v_sub_f32 v11, v0, v10
v_mul_f32 v11, s65, v11
v_exp_f32 v11, v11
v_mov_b32 v0, v10
v_mul_f32 v1, s65, v10
v_mul_f32 v2, v2, v11
s_nop 1
v_mul_f32_dpp v24, v11, v24 quad_perm:[0,0,0,0] row_mask:0xf bank_mask:0xf
v_mul_f32_dpp v25, v11, v25 quad_perm:[1,1,1,1] row_mask:0xf bank_mask:0xf
v_mul_f32_dpp v26, v11, v26 quad_perm:[0,0,0,0] row_mask:0xf bank_mask:0xf
v_mul_f32_dpp v27, v11, v27 quad_perm:[1,1,1,1] row_mask:0xf bank_mask:0xf
v_mul_f32_dpp v28, v11, v28 quad_perm:[0,0,0,0] row_mask:0xf bank_mask:0xf
v_mul_f32_dpp v29, v11, v29 quad_perm:[1,1,1,1] row_mask:0xf bank_mask:0xf
v_mul_f32_dpp v30, v11, v30 quad_perm:[0,0,0,0] row_mask:0xf bank_mask:0xf
v_mul_f32_dpp v31, v11, v31 quad_perm:[1,1,1,1] row_mask:0xf bank_mask:0xf
L_upd_ret_p2:
v_fma_f32 v12, v12, s65, -v1
v_fma_f32 v13, v13, s65, -v1
v_fma_f32 v14, v14, s65, -v1
v_fma_f32 v15, v15, s65, -v1
v_exp_f32 v12, v12
v_exp_f32 v13, v13
v_exp_f32 v14, v14
v_exp_f32 v15, v15
v_cvt_pk_bf16_f32 v10, v12, v12
v_add_f32 v11, v12, v13
v_add_f32 v3, v14, v15
v_and_b32 v16, v10, v4
v_and_b32 v17, v10, v5
v_and_b32 v18, v10, v6
v_and_b32 v19, v10, v7
v_cvt_pk_bf16_f32 v10, v13, v13
v_add_f32 v2, v2, v11
s_waitcnt vmcnt(16)
v_and_b32 v20, v10, v4
v_and_b32 v21, v10, v5
v_and_b32 v22, v10, v6
v_and_b32 v23, v10, v7
v_cvt_pk_bf16_f32 v10, v14, v14
v_add_f32 v2, v2, v3
v_mfma_f32_16x16x32_bf16 v[24:27], v[16:19], v[224:227], v[24:27]
v_mfma_f32_16x16x32_bf16 v[28:31], v[16:19], v[228:231], v[28:31]
v_and_b32 v16, v10, v4
v_and_b32 v17, v10, v5
v_and_b32 v18, v10, v6
v_and_b32 v19, v10, v7
v_cvt_pk_bf16_f32 v10, v15, v15
v_mfma_f32_16x16x32_bf16 v[24:27], v[20:23], v[232:235], v[24:27]
v_mfma_f32_16x16x32_bf16 v[28:31], v[20:23], v[236:239], v[28:31]
v_and_b32 v20, v10, v4
v_and_b32 v21, v10, v5
v_and_b32 v22, v10, v6
v_and_b32 v23, v10, v7
v_mfma_f32_16x16x32_bf16 v[24:27], v[16:19], v[240:243], v[24:27]
v_mfma_f32_16x16x32_bf16 v[28:31], v[16:19], v[244:247], v[28:31]
s_nop 0
v_mfma_f32_16x16x32_bf16 v[24:27], v[20:23], v[248:251], v[24:27]
v_mfma_f32_16x16x32_bf16 v[28:31], v[20:23], v[252:255], v[28:31]
s_cmp_eq_u32 s64, 0
s_cbranch_scc1 L_stream_end
L_loop:
s_cmp_eq_u32 s58, 0
s_cbranch_scc1 L_loop2
s_cmp_lg_u32 s58, 0
s_cbranch_scc1 L_notk_l
s_cmp_eq_u32 s59, 0
s_cbranch_scc1 L_notk_l
s_mov_b32 s62, 1
s_atomic_add s62, s[52:53], 0 glc
L_notk_l:
s_waitcnt vmcnt(8)
v_mfma_f32_16x16x32_bf16 v[12:15], v[64:67], v[32:35], 0
v_mfma_f32_16x16x32_bf16 v[12:15], v[68:71], v[36:39], v[12:15]
v_mfma_f32_16x16x32_bf16 v[12:15], v[72:75], v[40:43], v[12:15]
v_mfma_f32_16x16x32_bf16 v[12:15], v[76:79], v[44:47], v[12:15]
v_mfma_f32_16x16x32_bf16 v[12:15], v[80:83], v[48:51], v[12:15]
v_mfma_f32_16x16x32_bf16 v[12:15], v[84:87], v[52:55], v[12:15]
v_mfma_f32_16x16x32_bf16 v[12:15], v[88:91], v[56:59], v[12:15]
v_mfma_f32_16x16x32_bf16 v[12:15], v[92:95], v[60:63], v[12:15]
s_cmp_eq_u32 s58, 0
s_cbranch_scc1 L_dyn_l
s_sub_u32 s58, s58, 1
s_add_u32 s63, s63, 32
s_mov_b32 s64, 1
s_branch L_nxt_l
L_dyn_l:
s_waitcnt lgkmcnt(0)
s_mul_i32 s63, s62, 2
s_add_u32 s63, s63, s61
s_add_u32 s63, s63, 3584
s_cmp_eq_u32 s59, 0
s_cselect_b32 s63, 4096, s63
s_cmp_lt_u32 s63, 4096
s_cselect_b32 s46, 0x2000000, 0
s_cselect_b32 s50, 0x2000000, 0
s_cselect_b32 s64, 1, 0
s_cselect_b32 s63, s63, 0
L_nxt_l:
s_lshl_b32 s60, s63, 13
buffer_load_dwordx4 v[64:67], v8, s[44:47], s60 offen offset:0 nt
buffer_load_dwordx4 v[68:71], v8, s[44:47], s60 offen offset:64 nt
buffer_load_dwordx4 v[72:75], v8, s[44:47], s60 offen offset:128 nt
buffer_load_dwordx4 v[76:79], v8, s[44:47], s60 offen offset:192 nt
buffer_load_dwordx4 v[80:83], v8, s[44:47], s60 offen offset:256 nt
buffer_load_dwordx4 v[84:87], v8, s[44:47], s60 offen offset:320 nt
buffer_load_dwordx4 v[88:91], v8, s[44:47], s60 offen offset:384 nt
buffer_load_dwordx4 v[92:95], v8, s[44:47], s60 offen offset:448 nt
v_max3_f32 v10, v12, v13, v14
v_max_f32 v10, v10, v15
v_cmp_gt_f32 vcc, v10, v0
s_cbranch_vccz L_upd_ret_l
v_max_f32 v10, v10, v0
v_mov_b32 v11, v10
s_nop 1
v_permlane16_swap_b32 v11, v10
s_nop 1
v_max_f32 v10, v10, v11
v_mov_b32 v11, v10
s_nop 1
v_permlane32_swap_b32 v11, v10
s_nop 1
v_max_f32 v10, v10, v11
v_sub_f32 v11, v0, v10
v_mul_f32 v11, s65, v11
v_exp_f32 v11, v11
v_mov_b32 v0, v10
v_mul_f32 v1, s65, v10
v_mul_f32 v2, v2, v11
s_nop 1
v_mul_f32_dpp v24, v11, v24 quad_perm:[0,0,0,0] row_mask:0xf bank_mask:0xf
v_mul_f32_dpp v25, v11, v25 quad_perm:[1,1,1,1] row_mask:0xf bank_mask:0xf
v_mul_f32_dpp v26, v11, v26 quad_perm:[0,0,0,0] row_mask:0xf bank_mask:0xf
v_mul_f32_dpp v27, v11, v27 quad_perm:[1,1,1,1] row_mask:0xf bank_mask:0xf
v_mul_f32_dpp v28, v11, v28 quad_perm:[0,0,0,0] row_mask:0xf bank_mask:0xf
v_mul_f32_dpp v29, v11, v29 quad_perm:[1,1,1,1] row_mask:0xf bank_mask:0xf
v_mul_f32_dpp v30, v11, v30 quad_perm:[0,0,0,0] row_mask:0xf bank_mask:0xf
v_mul_f32_dpp v31, v11, v31 quad_perm:[1,1,1,1] row_mask:0xf bank_mask:0xf
L_upd_ret_l:
v_fma_f32 v12, v12, s65, -v1
v_fma_f32 v13, v13, s65, -v1
v_fma_f32 v14, v14, s65, -v1
v_fma_f32 v15, v15, s65, -v1
v_exp_f32 v12, v12
v_exp_f32 v13, v13
v_exp_f32 v14, v14
v_exp_f32 v15, v15
v_cvt_pk_bf16_f32 v10, v12, v12
v_add_f32 v11, v12, v13
v_add_f32 v3, v14, v15
v_and_b32 v16, v10, v4
v_and_b32 v17, v10, v5
v_and_b32 v18, v10, v6
v_and_b32 v19, v10, v7
v_cvt_pk_bf16_f32 v10, v13, v13
v_add_f32 v2, v2, v11
s_waitcnt vmcnt(8)
v_and_b32 v20, v10, v4
v_and_b32 v21, v10, v5
v_and_b32 v22, v10, v6
v_and_b32 v23, v10, v7
v_cvt_pk_bf16_f32 v10, v14, v14
v_add_f32 v2, v2, v3
v_mfma_f32_16x16x32_bf16 v[24:27], v[16:19], v[96:99], v[24:27]
v_mfma_f32_16x16x32_bf16 v[28:31], v[16:19], v[100:103], v[28:31]
v_and_b32 v16, v10, v4
v_and_b32 v17, v10, v5
v_and_b32 v18, v10, v6
v_and_b32 v19, v10, v7
v_cvt_pk_bf16_f32 v10, v15, v15
v_mfma_f32_16x16x32_bf16 v[24:27], v[20:23], v[104:107], v[24:27]
v_mfma_f32_16x16x32_bf16 v[28:31], v[20:23], v[108:111], v[28:31]
v_and_b32 v20, v10, v4
v_and_b32 v21, v10, v5
v_and_b32 v22, v10, v6
v_and_b32 v23, v10, v7
v_mfma_f32_16x16x32_bf16 v[24:27], v[16:19], v[112:115], v[24:27]
v_mfma_f32_16x16x32_bf16 v[28:31], v[16:19], v[116:119], v[28:31]
s_nop 0
v_mfma_f32_16x16x32_bf16 v[24:27], v[20:23], v[120:123], v[24:27]
v_mfma_f32_16x16x32_bf16 v[28:31], v[20:23], v[124:127], v[28:31]
buffer_load_dwordx4 v[96:99], v9, s[48:51], s60 offen offset:0 nt
buffer_load_dwordx4 v[100:103], v9, s[48:51], s60 offen offset:256 nt
buffer_load_dwordx4 v[104:107], v9, s[48:51], s60 offen offset:512 nt
buffer_load_dwordx4 v[108:111], v9, s[48:51], s60 offen offset:768 nt
buffer_load_dwordx4 v[112:115], v9, s[48:51], s60 offen offset:1024 nt
buffer_load_dwordx4 v[116:119], v9, s[48:51], s60 offen offset:1280 nt
buffer_load_dwordx4 v[120:123], v9, s[48:51], s60 offen offset:1536 nt
buffer_load_dwordx4 v[124:127], v9, s[48:51], s60 offen offset:1792 nt
s_branch L_loop
L_loop2:
s_cmp_lg_u32 s58, 0
s_cbranch_scc1 L_notk_la
s_cmp_eq_u32 s59, 0
s_cbranch_scc1 L_notk_la
s_mov_b32 s62, 1
s_atomic_add s62, s[52:53], 0 glc
L_notk_la:
s_waitcnt vmcnt(8)
v_mfma_f32_16x16x32_bf16 v[12:15], v[64:67], v[32:35], 0
v_mfma_f32_16x16x32_bf16 v[12:15], v[68:71], v[36:39], v[12:15]
v_mfma_f32_16x16x32_bf16 v[12:15], v[72:75], v[40:43], v[12:15]
v_mfma_f32_16x16x32_bf16 v[12:15], v[76:79], v[44:47], v[12:15]
v_mfma_f32_16x16x32_bf16 v[12:15], v[80:83], v[48:51], v[12:15]
v_mfma_f32_16x16x32_bf16 v[12:15], v[84:87], v[52:55], v[12:15]
v_mfma_f32_16x16x32_bf16 v[12:15], v[88:91], v[56:59], v[12:15]
v_mfma_f32_16x16x32_bf16 v[12:15], v[92:95], v[60:63], v[12:15]
s_cmp_eq_u32 s58, 0
s_cbranch_scc1 L_dyn_la
s_sub_u32 s58, s58, 1
s_add_u32 s63, s63, 32
s_mov_b32 s64, 1
s_branch L_nxt_la
L_dyn_la:
s_waitcnt lgkmcnt(0)
s_mul_i32 s63, s62, 2
s_add_u32 s63, s63, s61
s_add_u32 s63, s63, 3584
s_cmp_eq_u32 s59, 0
s_cselect_b32 s63, 4096, s63
s_cmp_lt_u32 s63, 4096
s_cselect_b32 s46, 0x2000000, 0
s_cselect_b32 s50, 0x2000000, 0
s_cselect_b32 s64, 1, 0
s_cselect_b32 s63, s63, 0
L_nxt_la:
s_lshl_b32 s60, s63, 13
buffer_load_dwordx4 v[64:67], v8, s[44:47], s60 offen offset:0 nt
buffer_load_dwordx4 v[68:71], v8, s[44:47], s60 offen offset:64 nt
buffer_load_dwordx4 v[72:75], v8, s[44:47], s60 offen offset:128 nt
buffer_load_dwordx4 v[76:79], v8, s[44:47], s60 offen offset:192 nt
buffer_load_dwordx4 v[80:83], v8, s[44:47], s60 offen offset:256 nt
buffer_load_dwordx4 v[84:87], v8, s[44:47], s60 offen offset:320 nt
buffer_load_dwordx4 v[88:91], v8, s[44:47], s60 offen offset:384 nt
buffer_load_dwordx4 v[92:95], v8, s[44:47], s60 offen offset:448 nt
buffer_load_dwordx4 v[160:163], v9, s[48:51], s60 offen offset:0 nt
buffer_load_dwordx4 v[164:167], v9, s[48:51], s60 offen offset:256 nt
buffer_load_dwordx4 v[168:171], v9, s[48:51], s60 offen offset:512 nt
buffer_load_dwordx4 v[172:175], v9, s[48:51], s60 offen offset:768 nt
buffer_load_dwordx4 v[176:179], v9, s[48:51], s60 offen offset:1024 nt
buffer_load_dwordx4 v[180:183], v9, s[48:51], s60 offen offset:1280 nt
buffer_load_dwordx4 v[184:187], v9, s[48:51], s60 offen offset:1536 nt
buffer_load_dwordx4 v[188:191], v9, s[48:51], s60 offen offset:1792 nt
v_max3_f32 v10, v12, v13, v14
v_max_f32 v10, v10, v15
v_cmp_gt_f32 vcc, v10, v0
s_cbranch_vccz L_upd_ret_la
v_max_f32 v10, v10, v0
v_mov_b32 v11, v10
s_nop 1
v_permlane16_swap_b32 v11, v10
s_nop 1
v_max_f32 v10, v10, v11
v_mov_b32 v11, v10
s_nop 1
v_permlane32_swap_b32 v11, v10
s_nop 1
v_max_f32 v10, v10, v11
v_sub_f32 v11, v0, v10
v_mul_f32 v11, s65, v11
v_exp_f32 v11, v11
v_mov_b32 v0, v10
v_mul_f32 v1, s65, v10
v_mul_f32 v2, v2, v11
s_nop 1
v_mul_f32_dpp v24, v11, v24 quad_perm:[0,0,0,0] row_mask:0xf bank_mask:0xf
v_mul_f32_dpp v25, v11, v25 quad_perm:[1,1,1,1] row_mask:0xf bank_mask:0xf
v_mul_f32_dpp v26, v11, v26 quad_perm:[0,0,0,0] row_mask:0xf bank_mask:0xf
v_mul_f32_dpp v27, v11, v27 quad_perm:[1,1,1,1] row_mask:0xf bank_mask:0xf
v_mul_f32_dpp v28, v11, v28 quad_perm:[0,0,0,0] row_mask:0xf bank_mask:0xf
v_mul_f32_dpp v29, v11, v29 quad_perm:[1,1,1,1] row_mask:0xf bank_mask:0xf
v_mul_f32_dpp v30, v11, v30 quad_perm:[0,0,0,0] row_mask:0xf bank_mask:0xf
v_mul_f32_dpp v31, v11, v31 quad_perm:[1,1,1,1] row_mask:0xf bank_mask:0xf
L_upd_ret_la:
v_fma_f32 v12, v12, s65, -v1
v_fma_f32 v13, v13, s65, -v1
v_fma_f32 v14, v14, s65, -v1
v_fma_f32 v15, v15, s65, -v1
v_exp_f32 v12, v12
v_exp_f32 v13, v13
v_exp_f32 v14, v14
v_exp_f32 v15, v15
v_cvt_pk_bf16_f32 v10, v12, v12
v_add_f32 v11, v12, v13
v_add_f32 v3, v14, v15
v_and_b32 v16, v10, v4
v_and_b32 v17, v10, v5
v_and_b32 v18, v10, v6
v_and_b32 v19, v10, v7
v_cvt_pk_bf16_f32 v10, v13, v13
v_add_f32 v2, v2, v11
s_waitcnt vmcnt(16)
v_and_b32 v20, v10, v4
v_and_b32 v21, v10, v5
v_and_b32 v22, v10, v6
v_and_b32 v23, v10, v7
v_cvt_pk_bf16_f32 v10, v14, v14
v_add_f32 v2, v2, v3
v_mfma_f32_16x16x32_bf16 v[24:27], v[16:19], v[96:99], v[24:27]
v_mfma_f32_16x16x32_bf16 v[28:31], v[16:19], v[100:103], v[28:31]
v_and_b32 v16, v10, v4
v_and_b32 v17, v10, v5
v_and_b32 v18, v10, v6
v_and_b32 v19, v10, v7
v_cvt_pk_bf16_f32 v10, v15, v15
v_mfma_f32_16x16x32_bf16 v[24:27], v[20:23], v[104:107], v[24:27]
v_mfma_f32_16x16x32_bf16 v[28:31], v[20:23], v[108:111], v[28:31]
v_and_b32 v20, v10, v4
v_and_b32 v21, v10, v5
v_and_b32 v22, v10, v6
v_and_b32 v23, v10, v7
v_mfma_f32_16x16x32_bf16 v[24:27], v[16:19], v[112:115], v[24:27]
v_mfma_f32_16x16x32_bf16 v[28:31], v[16:19], v[116:119], v[28:31]
s_nop 0
v_mfma_f32_16x16x32_bf16 v[24:27], v[20:23], v[120:123], v[24:27]
v_mfma_f32_16x16x32_bf16 v[28:31], v[20:23], v[124:127], v[28:31]
s_cmp_eq_u32 s64, 0
s_cbranch_scc1 L_stream_end
s_cmp_lg_u32 s58, 0
s_cbranch_scc1 L_notk_lb
s_cmp_eq_u32 s59, 0
s_cbranch_scc1 L_notk_lb
s_mov_b32 s62, 1
s_atomic_add s62, s[52:53], 0 glc
L_notk_lb:
s_waitcnt vmcnt(8)
v_mfma_f32_16x16x32_bf16 v[12:15], v[64:67], v[32:35], 0
v_mfma_f32_16x16x32_bf16 v[12:15], v[68:71], v[36:39], v[12:15]
v_mfma_f32_16x16x32_bf16 v[12:15], v[72:75], v[40:43], v[12:15]
v_mfma_f32_16x16x32_bf16 v[12:15], v[76:79], v[44:47], v[12:15]
v_mfma_f32_16x16x32_bf16 v[12:15], v[80:83], v[48:51], v[12:15]
v_mfma_f32_16x16x32_bf16 v[12:15], v[84:87], v[52:55], v[12:15]
v_mfma_f32_16x16x32_bf16 v[12:15], v[88:91], v[56:59], v[12:15]
v_mfma_f32_16x16x32_bf16 v[12:15], v[92:95], v[60:63], v[12:15]
s_cmp_eq_u32 s58, 0
s_cbranch_scc1 L_dyn_lb
s_sub_u32 s58, s58, 1
s_add_u32 s63, s63, 32
s_mov_b32 s64, 1
s_branch L_nxt_lb
L_dyn_lb:
s_waitcnt lgkmcnt(0)
s_mul_i32 s63, s62, 2
s_add_u32 s63, s63, s61
s_add_u32 s63, s63, 3584
s_cmp_eq_u32 s59, 0
s_cselect_b32 s63, 4096, s63
s_cmp_lt_u32 s63, 4096
s_cselect_b32 s46, 0x2000000, 0
s_cselect_b32 s50, 0x2000000, 0
s_cselect_b32 s64, 1, 0
s_cselect_b32 s63, s63, 0
L_nxt_lb:
s_lshl_b32 s60, s63, 13
buffer_load_dwordx4 v[64:67], v8, s[44:47], s60 offen offset:0 nt
buffer_load_dwordx4 v[68:71], v8, s[44:47], s60 offen offset:64 nt
buffer_load_dwordx4 v[72:75], v8, s[44:47], s60 offen offset:128 nt
buffer_load_dwordx4 v[76:79], v8, s[44:47], s60 offen offset:192 nt
buffer_load_dwordx4 v[80:83], v8, s[44:47], s60 offen offset:256 nt
buffer_load_dwordx4 v[84:87], v8, s[44:47], s60 offen offset:320 nt
buffer_load_dwordx4 v[88:91], v8, s[44:47], s60 offen offset:384 nt
buffer_load_dwordx4 v[92:95], v8, s[44:47], s60 offen offset:448 nt
buffer_load_dwordx4 v[96:99], v9, s[48:51], s60 offen offset:0 nt
buffer_load_dwordx4 v[100:103], v9, s[48:51], s60 offen offset:256 nt
buffer_load_dwordx4 v[104:107], v9, s[48:51], s60 offen offset:512 nt
buffer_load_dwordx4 v[108:111], v9, s[48:51], s60 offen offset:768 nt
buffer_load_dwordx4 v[112:115], v9, s[48:51], s60 offen offset:1024 nt
buffer_load_dwordx4 v[116:119], v9, s[48:51], s60 offen offset:1280 nt
buffer_load_dwordx4 v[120:123], v9, s[48:51], s60 offen offset:1536 nt
buffer_load_dwordx4 v[124:127], v9, s[48:51], s60 offen offset:1792 nt
v_max3_f32 v10, v12, v13, v14
v_max_f32 v10, v10, v15
v_cmp_gt_f32 vcc, v10, v0
s_cbranch_vccz L_upd_ret_lb
v_max_f32 v10, v10, v0
v_mov_b32 v11, v10
s_nop 1
v_permlane16_swap_b32 v11, v10
s_nop 1
v_max_f32 v10, v10, v11
v_mov_b32 v11, v10
s_nop 1
v_permlane32_swap_b32 v11, v10
s_nop 1
v_max_f32 v10, v10, v11
v_sub_f32 v11, v0, v10
v_mul_f32 v11, s65, v11
v_exp_f32 v11, v11
v_mov_b32 v0, v10
v_mul_f32 v1, s65, v10
v_mul_f32 v2, v2, v11
s_nop 1
v_mul_f32_dpp v24, v11, v24 quad_perm:[0,0,0,0] row_mask:0xf bank_mask:0xf
v_mul_f32_dpp v25, v11, v25 quad_perm:[1,1,1,1] row_mask:0xf bank_mask:0xf
v_mul_f32_dpp v26, v11, v26 quad_perm:[0,0,0,0] row_mask:0xf bank_mask:0xf
v_mul_f32_dpp v27, v11, v27 quad_perm:[1,1,1,1] row_mask:0xf bank_mask:0xf
v_mul_f32_dpp v28, v11, v28 quad_perm:[0,0,0,0] row_mask:0xf bank_mask:0xf
v_mul_f32_dpp v29, v11, v29 quad_perm:[1,1,1,1] row_mask:0xf bank_mask:0xf
v_mul_f32_dpp v30, v11, v30 quad_perm:[0,0,0,0] row_mask:0xf bank_mask:0xf
v_mul_f32_dpp v31, v11, v31 quad_perm:[1,1,1,1] row_mask:0xf bank_mask:0xf
L_upd_ret_lb:
v_fma_f32 v12, v12, s65, -v1
v_fma_f32 v13, v13, s65, -v1
v_fma_f32 v14, v14, s65, -v1
v_fma_f32 v15, v15, s65, -v1
v_exp_f32 v12, v12
v_exp_f32 v13, v13
v_exp_f32 v14, v14
v_exp_f32 v15, v15
v_cvt_pk_bf16_f32 v10, v12, v12
v_add_f32 v11, v12, v13
v_add_f32 v3, v14, v15
v_and_b32 v16, v10, v4
v_and_b32 v17, v10, v5
v_and_b32 v18, v10, v6
v_and_b32 v19, v10, v7
v_cvt_pk_bf16_f32 v10, v13, v13
v_add_f32 v2, v2, v11
s_waitcnt vmcnt(16)
v_and_b32 v20, v10, v4
v_and_b32 v21, v10, v5
v_and_b32 v22, v10, v6
v_and_b32 v23, v10, v7
v_cvt_pk_bf16_f32 v10, v14, v14
v_add_f32 v2, v2, v3
v_mfma_f32_16x16x32_bf16 v[24:27], v[16:19], v[160:163], v[24:27]
v_mfma_f32_16x16x32_bf16 v[28:31], v[16:19], v[164:167], v[28:31]
v_and_b32 v16, v10, v4
v_and_b32 v17, v10, v5
v_and_b32 v18, v10, v6
v_and_b32 v19, v10, v7
v_cvt_pk_bf16_f32 v10, v15, v15
v_mfma_f32_16x16x32_bf16 v[24:27], v[20:23], v[168:171], v[24:27]
v_mfma_f32_16x16x32_bf16 v[28:31], v[20:23], v[172:175], v[28:31]
v_and_b32 v20, v10, v4
v_and_b32 v21, v10, v5
v_and_b32 v22, v10, v6
v_and_b32 v23, v10, v7
v_mfma_f32_16x16x32_bf16 v[24:27], v[16:19], v[176:179], v[24:27]
v_mfma_f32_16x16x32_bf16 v[28:31], v[16:19], v[180:183], v[28:31]
s_nop 0
v_mfma_f32_16x16x32_bf16 v[24:27], v[20:23], v[184:187], v[24:27]
v_mfma_f32_16x16x32_bf16 v[28:31], v[20:23], v[188:191], v[28:31]
s_cmp_lg_u32 s64, 0
s_cbranch_scc1 L_loop2
s_branch L_stream_end
s_cmp_lg_u32 s64, 0
s_cbranch_scc1 L_loop
L_stream_end:
v_mov_b32 v11, v2
s_nop 1
v_permlane16_swap_b32 v11, v2
s_nop 1
v_add_f32 v2, v2, v11
v_mov_b32 v11, v2
s_nop 1
v_permlane32_swap_b32 v11, v2
s_nop 1
v_add_f32 v2, v2, v11
v_mov_b32 v12, v1
v_mov_b32 v13, v2
v_mbcnt_lo_u32_b32 v3, -1, 0
v_mbcnt_hi_u32_b32 v3, -1, v3
s_lshl_b32 s42, s8, 4
s_add_u32 s42, s42, 1152
v_and_b32 v10, 1, v3
v_lshlrev_b32 v10, 3, v10
v_add_u32 v10, s42, v10
s_mov_b64 exec, 3
ds_write_b64 v10, v[12:13]
s_mov_b64 exec, -1
s_lshl_b32 s42, s8, 11
s_add_u32 s42, s42, 8192
v_and_b32 v10, 15, v3
v_lshrrev_b32 v11, 4, v3
v_lshlrev_b32 v10, 5, v10
v_lshl_add_u32 v10, v11, 3, v10
v_add_u32 v10, s42, v10
ds_write_b32 v10, v24 offset:0
ds_write_b32 v10, v25 offset:1024
ds_write_b32 v10, v26 offset:4
ds_write_b32 v10, v27 offset:1028
ds_write_b32 v10, v28 offset:512
ds_write_b32 v10, v29 offset:1536
ds_write_b32 v10, v30 offset:516
ds_write_b32 v10, v31 offset:1540
s_waitcnt lgkmcnt(0)
s_barrier
s_endpgm
L_service:
s_load_dwordx16 s[16:31], s[0:1], 0
s_load_dwordx8 s[32:39], s[0:1], 64
s_setprio 3
v_lshlrev_b32 v60, 4, v1
v_lshlrev_b32 v61, 1, v1
v_mov_b32 v12, 0
v_lshrrev_b32 v8, 2, v3
v_bfe_u32 v9, v3, 1, 1
v_mov_b32 v10, 0xffff
v_lshlrev_b32 v9, 4, v9
v_lshlrev_b32 v10, v9, v10
v_cmp_eq_u32 vcc, 0, v8
v_cmp_eq_u32 s[76:77], 1, v8
v_cmp_eq_u32 s[78:79], 2, v8
v_cmp_eq_u32 s[80:81], 3, v8
s_nop 1
v_cndmask_b32 v4, 0, v10, vcc
v_cndmask_b32 v5, 0, v10, s[76:77]
v_cndmask_b32 v6, 0, v10, s[78:79]
v_cndmask_b32 v7, 0, v10, s[80:81]
s_waitcnt lgkmcnt(0)
s_mov_b32 s48, s40
s_mov_b32 s49, s41
s_mov_b32 s50, 4194304
s_mov_b32 s51, 0x20000
s_cmp_lg_u32 s9, 0
s_cbranch_scc1 L_nob0n_v
s_barrier
L_nob0n_v:
buffer_load_dwordx2 v[14:15], v12, s[48:51], 0 offen offset:0 sc1
s_cmp_eq_u32 s9, 0
s_cbranch_scc1 L_noprod
s_mov_b32 s44, s22
s_mov_b32 s45, s23
s_mov_b32 s46, 3670016
s_mov_b32 s47, 0x20000
s_mov_b32 s56, s16
s_mov_b32 s57, s17
s_mov_b32 s58, 896
s_mov_b32 s59, 0x20000
v_bfe_u32 v8, v1, 3, 1
v_lshl_add_u32 v8, v2, 1, v8
s_mov_b32 s42, 458752
v_mul_lo_u32 v62, s42, v8
v_and_b32 v8, 7, v1
v_lshl_add_u32 v62, v8, 4, v62
v_and_b32 v8, 1, v1
v_lshl_add_u32 v8, v2, 1, v8
v_mul_u32_u24 v63, 112, v8
s_mul_i32 s13, s3, 56
s_lshr_b32 s42, s5, 3
s_lshl_b32 s42, s42, 1
s_add_u32 s10, s42, s6
s_lshl_b32 s11, s4, 10
s_lshl_b32 s42, s10, 7
s_add_u32 s11, s11, s42
s_mul_i32 s42, s3, 229376
s_add_u32 s11, s11, s42
s_add_u32 s12, s11, 0
buffer_load_dwordx4 v[64:67], v62, s[44:47], s12 offen nt
s_add_u32 s12, s11, 8192
buffer_load_dwordx4 v[68:71], v62, s[44:47], s12 offen nt
s_add_u32 s12, s11, 16384
buffer_load_dwordx4 v[72:75], v62, s[44:47], s12 offen nt
s_add_u32 s12, s11, 24576
buffer_load_dwordx4 v[76:79], v62, s[44:47], s12 offen nt
buffer_load_dwordx4 v[16:19], v63, s[56:59], s13 offen offset:0
buffer_load_dwordx4 v[20:23], v63, s[56:59], s13 offen offset:16
buffer_load_dwordx4 v[24:27], v63, s[56:59], s13 offen offset:32
buffer_load_dwordx2 v[28:29], v63, s[56:59], s13 offen offset:48
s_add_u32 s12, s11, 32768
buffer_load_dwordx4 v[80:83], v62, s[44:47], s12 offen nt
s_add_u32 s12, s11, 40960
buffer_load_dwordx4 v[84:87], v62, s[44:47], s12 offen nt
s_add_u32 s12, s11, 49152
buffer_load_dwordx4 v[88:91], v62, s[44:47], s12 offen nt
s_add_u32 s12, s11, 57344
buffer_load_dwordx4 v[92:95], v62, s[44:47], s12 offen nt
s_add_u32 s12, s11, 65536
buffer_load_dwordx4 v[96:99], v62, s[44:47], s12 offen nt
s_add_u32 s12, s11, 73728
buffer_load_dwordx4 v[100:103], v62, s[44:47], s12 offen nt
s_add_u32 s12, s11, 81920
buffer_load_dwordx4 v[104:107], v62, s[44:47], s12 offen nt
s_add_u32 s12, s11, 90112
buffer_load_dwordx4 v[108:111], v62, s[44:47], s12 offen nt
s_add_u32 s12, s11, 98304
buffer_load_dwordx4 v[112:115], v62, s[44:47], s12 offen nt
s_add_u32 s12, s11, 106496
buffer_load_dwordx4 v[116:119], v62, s[44:47], s12 offen nt
s_add_u32 s12, s11, 114688
buffer_load_dwordx4 v[120:123], v62, s[44:47], s12 offen nt
s_add_u32 s12, s11, 122880
buffer_load_dwordx4 v[124:127], v62, s[44:47], s12 offen nt
s_add_u32 s12, s11, 131072
buffer_load_dwordx4 v[128:131], v62, s[44:47], s12 offen nt
s_add_u32 s12, s11, 139264
buffer_load_dwordx4 v[132:135], v62, s[44:47], s12 offen nt
s_add_u32 s12, s11, 147456
buffer_load_dwordx4 v[136:139], v62, s[44:47], s12 offen nt
s_add_u32 s12, s11, 155648
buffer_load_dwordx4 v[140:143], v62, s[44:47], s12 offen nt
s_add_u32 s12, s11, 163840
buffer_load_dwordx4 v[144:147], v62, s[44:47], s12 offen nt
s_add_u32 s12, s11, 172032
buffer_load_dwordx4 v[148:151], v62, s[44:47], s12 offen nt
s_add_u32 s12, s11, 180224
buffer_load_dwordx4 v[152:155], v62, s[44:47], s12 offen nt
s_add_u32 s12, s11, 188416
buffer_load_dwordx4 v[156:159], v62, s[44:47], s12 offen nt
s_add_u32 s12, s11, 196608
buffer_load_dwordx4 v[160:163], v62, s[44:47], s12 offen nt
s_add_u32 s12, s11, 204800
buffer_load_dwordx4 v[164:167], v62, s[44:47], s12 offen nt
s_add_u32 s12, s11, 212992
buffer_load_dwordx4 v[168:171], v62, s[44:47], s12 offen nt
s_add_u32 s12, s11, 221184
buffer_load_dwordx4 v[172:175], v62, s[44:47], s12 offen nt
v_mov_b32 v36, 0
v_mov_b32 v37, 7168
s_mov_b64 exec, 1
ds_write_b32 v37, v36
s_mov_b64 exec, -1
s_waitcnt lgkmcnt(0)
s_barrier
s_cmp_eq_u32 s3, 0
s_cbranch_scc0 L_p_rst_b
s_mov_b64 exec, 1
s_cmp_lt_u32 s10, 2
s_cbranch_scc0 L_p_nocnt
s_mul_i32 s42, s4, 2
s_add_u32 s42, s42, s10
s_lshl_b32 s42, s42, 8
s_add_u32 s42, s42, 4096
buffer_atomic_swap v12, v12, s[48:51], s42 offen
s_branch L_p_cnt_done
L_p_nocnt:
buffer_load_dword v30, v12, s[48:51], 0 offen offset:0
L_p_cnt_done:
buffer_load_dword v31, v12, s[48:51], 0 offen offset:0
buffer_load_dword v32, v12, s[48:51], 0 offen offset:0
buffer_load_dword v33, v12, s[48:51], 0 offen offset:0
buffer_load_dword v34, v12, s[48:51], 0 offen offset:0
s_mov_b64 exec, -1
s_branch L_p_go
L_p_rst_b:
v_mov_b32 v36, -1
v_mov_b32 v37, -1
v_mov_b32 v38, -1
v_mov_b32 v39, -1
s_mul_i32 s74, s2, 4096
s_add_u32 s74, s74, 65536
s_mul_i32 s75, s2, 1792
s_add_u32 s75, s75, 1114112
buffer_store_dwordx4 v[36:39], v60, s[48:51], s74 offen sc1
buffer_store_dwordx4 v[36:39], v60, s[48:51], s74 offen offset:1024 sc1
buffer_store_dwordx4 v[36:39], v60, s[48:51], s75 offen sc1
s_mov_b32 exec_hi, 0xffff
buffer_store_dwordx4 v[36:39], v60, s[48:51], s75 offen offset:1024 sc1
s_mov_b64 exec, 1
buffer_store_dwordx4 v[36:39], v60, s[48:51], s74 offen offset:2048 sc1
s_mov_b64 exec, -1
L_p_go:
v_mov_b32 v13, 0x0c0c0c0c
s_mov_b32 s42, 0x01000100
s_mov_b32 s43, 0x03020302
v_bfi_b32 v44, v4, s42, v13
v_bfi_b32 v45, v5, s42, v13
v_bfi_b32 v46, v6, s42, v13
v_bfi_b32 v47, v7, s42, v13
v_bfi_b32 v48, v4, s43, v13
v_bfi_b32 v49, v5, s43, v13
v_bfi_b32 v50, v6, s43, v13
v_bfi_b32 v51, v7, s43, v13
s_waitcnt vmcnt(29)
v_perm_b32 v52, v16, v16, v44
v_perm_b32 v53, v16, v16, v45
v_perm_b32 v54, v16, v16, v46
v_perm_b32 v55, v16, v16, v47
v_perm_b32 v56, v16, v16, v48
v_perm_b32 v57, v16, v16, v49
v_perm_b32 v58, v16, v16, v50
v_perm_b32 v59, v16, v16, v51
v_mfma_f32_16x16x32_bf16 v[8:11], v[52:55], v[64:67], 0
v_perm_b32 v52, v17, v17, v44
v_perm_b32 v53, v17, v17, v45
v_perm_b32 v54, v17, v17, v46
v_perm_b32 v55, v17, v17, v47
v_mfma_f32_16x16x32_bf16 v[8:11], v[56:59], v[68:71], v[8:11]
v_perm_b32 v56, v17, v17, v48
v_perm_b32 v57, v17, v17, v49
v_perm_b32 v58, v17, v17, v50
v_perm_b32 v59, v17, v17, v51
v_mfma_f32_16x16x32_bf16 v[8:11], v[52:55], v[72:75], v[8:11]
v_perm_b32 v52, v18, v18, v44
v_perm_b32 v53, v18, v18, v45
v_perm_b32 v54, v18, v18, v46
v_perm_b32 v55, v18, v18, v47
v_mfma_f32_16x16x32_bf16 v[8:11], v[56:59], v[76:79], v[8:11]
v_perm_b32 v56, v18, v18, v48
v_perm_b32 v57, v18, v18, v49
v_perm_b32 v58, v18, v18, v50
v_perm_b32 v59, v18, v18, v51
s_waitcnt vmcnt(28)
v_mfma_f32_16x16x32_bf16 v[8:11], v[52:55], v[80:83], v[8:11]
v_perm_b32 v52, v19, v19, v44
v_perm_b32 v53, v19, v19, v45
v_perm_b32 v54, v19, v19, v46
v_perm_b32 v55, v19, v19, v47
s_waitcnt vmcnt(27)
v_mfma_f32_16x16x32_bf16 v[8:11], v[56:59], v[84:87], v[8:11]
v_perm_b32 v56, v19, v19, v48
v_perm_b32 v57, v19, v19, v49
v_perm_b32 v58, v19, v19, v50
v_perm_b32 v59, v19, v19, v51
s_waitcnt vmcnt(26)
v_mfma_f32_16x16x32_bf16 v[8:11], v[52:55], v[88:91], v[8:11]
v_perm_b32 v52, v20, v20, v44
v_perm_b32 v53, v20, v20, v45
v_perm_b32 v54, v20, v20, v46
v_perm_b32 v55, v20, v20, v47
s_waitcnt vmcnt(25)
v_mfma_f32_16x16x32_bf16 v[8:11], v[56:59], v[92:95], v[8:11]
v_perm_b32 v56, v20, v20, v48
v_perm_b32 v57, v20, v20, v49
v_perm_b32 v58, v20, v20, v50
v_perm_b32 v59, v20, v20, v51
s_waitcnt vmcnt(24)
v_mfma_f32_16x16x32_bf16 v[8:11], v[52:55], v[96:99], v[8:11]
v_perm_b32 v52, v21, v21, v44
v_perm_b32 v53, v21, v21, v45
v_perm_b32 v54, v21, v21, v46
v_perm_b32 v55, v21, v21, v47
s_waitcnt vmcnt(23)
v_mfma_f32_16x16x32_bf16 v[8:11], v[56:59], v[100:103], v[8:11]
v_perm_b32 v56, v21, v21, v48
v_perm_b32 v57, v21, v21, v49
v_perm_b32 v58, v21, v21, v50
v_perm_b32 v59, v21, v21, v51
s_waitcnt vmcnt(22)
v_mfma_f32_16x16x32_bf16 v[8:11], v[52:55], v[104:107], v[8:11]
v_perm_b32 v52, v22, v22, v44
v_perm_b32 v53, v22, v22, v45
v_perm_b32 v54, v22, v22, v46
v_perm_b32 v55, v22, v22, v47
s_waitcnt vmcnt(21)
v_mfma_f32_16x16x32_bf16 v[8:11], v[56:59], v[108:111], v[8:11]
v_perm_b32 v56, v22, v22, v48
v_perm_b32 v57, v22, v22, v49
v_perm_b32 v58, v22, v22, v50
v_perm_b32 v59, v22, v22, v51
s_waitcnt vmcnt(20)
v_mfma_f32_16x16x32_bf16 v[8:11], v[52:55], v[112:115], v[8:11]
v_perm_b32 v52, v23, v23, v44
v_perm_b32 v53, v23, v23, v45
v_perm_b32 v54, v23, v23, v46
v_perm_b32 v55, v23, v23, v47
s_waitcnt vmcnt(19)
v_mfma_f32_16x16x32_bf16 v[8:11], v[56:59], v[116:119], v[8:11]
v_perm_b32 v56, v23, v23, v48
v_perm_b32 v57, v23, v23, v49
v_perm_b32 v58, v23, v23, v50
v_perm_b32 v59, v23, v23, v51
s_waitcnt vmcnt(18)
v_mfma_f32_16x16x32_bf16 v[8:11], v[52:55], v[120:123], v[8:11]
v_perm_b32 v52, v24, v24, v44
v_perm_b32 v53, v24, v24, v45
v_perm_b32 v54, v24, v24, v46
v_perm_b32 v55, v24, v24, v47
s_waitcnt vmcnt(17)
v_mfma_f32_16x16x32_bf16 v[8:11], v[56:59], v[124:127], v[8:11]
v_perm_b32 v56, v24, v24, v48
v_perm_b32 v57, v24, v24, v49
v_perm_b32 v58, v24, v24, v50
v_perm_b32 v59, v24, v24, v51
s_waitcnt vmcnt(16)
v_mfma_f32_16x16x32_bf16 v[8:11], v[52:55], v[128:131], v[8:11]
v_perm_b32 v52, v25, v25, v44
v_perm_b32 v53, v25, v25, v45
v_perm_b32 v54, v25, v25, v46
v_perm_b32 v55, v25, v25, v47
s_waitcnt vmcnt(15)
v_mfma_f32_16x16x32_bf16 v[8:11], v[56:59], v[132:135], v[8:11]
v_perm_b32 v56, v25, v25, v48
v_perm_b32 v57, v25, v25, v49
v_perm_b32 v58, v25, v25, v50
v_perm_b32 v59, v25, v25, v51
s_waitcnt vmcnt(14)
v_mfma_f32_16x16x32_bf16 v[8:11], v[52:55], v[136:139], v[8:11]
v_perm_b32 v52, v26, v26, v44
v_perm_b32 v53, v26, v26, v45
v_perm_b32 v54, v26, v26, v46
v_perm_b32 v55, v26, v26, v47
s_waitcnt vmcnt(13)
v_mfma_f32_16x16x32_bf16 v[8:11], v[56:59], v[140:143], v[8:11]
v_perm_b32 v56, v26, v26, v48
v_perm_b32 v57, v26, v26, v49
v_perm_b32 v58, v26, v26, v50
v_perm_b32 v59, v26, v26, v51
s_waitcnt vmcnt(12)
v_mfma_f32_16x16x32_bf16 v[8:11], v[52:55], v[144:147], v[8:11]
v_perm_b32 v52, v27, v27, v44
v_perm_b32 v53, v27, v27, v45
v_perm_b32 v54, v27, v27, v46
v_perm_b32 v55, v27, v27, v47
s_waitcnt vmcnt(11)
v_mfma_f32_16x16x32_bf16 v[8:11], v[56:59], v[148:151], v[8:11]
v_perm_b32 v56, v27, v27, v48
v_perm_b32 v57, v27, v27, v49
v_perm_b32 v58, v27, v27, v50
v_perm_b32 v59, v27, v27, v51
s_waitcnt vmcnt(10)
v_mfma_f32_16x16x32_bf16 v[8:11], v[52:55], v[152:155], v[8:11]
v_perm_b32 v52, v28, v28, v44
v_perm_b32 v53, v28, v28, v45
v_perm_b32 v54, v28, v28, v46
v_perm_b32 v55, v28, v28, v47
s_waitcnt vmcnt(9)
v_mfma_f32_16x16x32_bf16 v[8:11], v[56:59], v[156:159], v[8:11]
v_perm_b32 v56, v28, v28, v48
v_perm_b32 v57, v28, v28, v49
v_perm_b32 v58, v28, v28, v50
v_perm_b32 v59, v28, v28, v51
s_waitcnt vmcnt(8)
v_mfma_f32_16x16x32_bf16 v[8:11], v[52:55], v[160:163], v[8:11]
v_perm_b32 v52, v29, v29, v44
v_perm_b32 v53, v29, v29, v45
v_perm_b32 v54, v29, v29, v46
v_perm_b32 v55, v29, v29, v47
s_waitcnt vmcnt(7)
v_mfma_f32_16x16x32_bf16 v[8:11], v[56:59], v[164:167], v[8:11]
v_perm_b32 v56, v29, v29, v48
v_perm_b32 v57, v29, v29, v49
v_perm_b32 v58, v29, v29, v50
v_perm_b32 v59, v29, v29, v51
s_waitcnt vmcnt(6)
v_mfma_f32_16x16x32_bf16 v[8:11], v[52:55], v[168:171], v[8:11]
s_waitcnt vmcnt(5)
v_mfma_f32_16x16x32_bf16 v[8:11], v[56:59], v[172:175], v[8:11]
v_readfirstlane_b32 s66, v14
v_readfirstlane_b32 s67, v15
s_nop 7
s_add_u32 s66, s66, 2654435761
s_addc_u32 s67, s67, 2135587861
v_mov_b32 v14, s66
v_mov_b32 v15, s67
v_mov_b32 v16, 7168
s_cmp_eq_u32 s3, 0
s_cbranch_scc1 L_p_a
ds_write_b128 v60, v[8:11] offset:6144
s_waitcnt lgkmcnt(0)
v_mov_b32 v17, 1
s_mov_b64 exec, 1
ds_write_b32 v16, v17
s_mov_b64 exec, -1
s_branch L_b_ready
L_p_a:
s_mov_b32 s12, 0
L_p_wait:
ds_read_b32 v18, v16
s_waitcnt lgkmcnt(0)
v_cmp_eq_u32 vcc, 1, v18
s_nop 1
s_cmp_eq_u64 vcc, -1
s_cbranch_scc1 L_p_got
s_add_u32 s12, s12, 1
s_cmp_lt_u32 s12, 4194304
s_cbranch_scc1 L_p_wait
L_p_got:
ds_read_b128 v[20:23], v60 offset:6144
s_waitcnt lgkmcnt(0)
v_add_f32 v8, v8, v20
v_add_f32 v9, v9, v21
v_add_f32 v10, v10, v22
v_add_f32 v11, v11, v23
s_nop 1
v_add_f32_dpp v8, v9, v8 row_ror:8 row_mask:0xf bank_mask:0xf
v_add_f32_dpp v10, v11, v10 row_ror:8 row_mask:0xf bank_mask:0xf
s_nop 0
v_cvt_pk_bf16_f32 v12, v8, v10
v_mov_b32 v13, v12
v_and_b32 v8, 7, v1
v_lshlrev_b32 v8, 5, v8
v_lshrrev_b32 v9, 5, v1
v_permlane16_swap_b32 v12, v13
v_lshl_add_u32 v8, v9, 4, v8
s_lshl_b32 s42, s10, 8
s_lshl_b32 s43, s4, 11
s_add_u32 s42, s42, s43
s_add_u32 s42, s42, 16384
s_waitcnt vmcnt(0)
s_mov_b32 exec_lo, 0xff
s_mov_b32 exec_hi, 0xff
buffer_store_dwordx4 v[12:15], v8, s[48:51], s42 offen sc1
s_mov_b64 exec, -1
s_branch L_pollq_setup
L_noprod:
s_cmp_eq_u32 s3, 0
s_cbranch_scc0 L_np_b
s_waitcnt vmcnt(0)
v_readfirstlane_b32 s66, v14
v_readfirstlane_b32 s67, v15
s_nop 3
s_add_u32 s66, s66, 2654435761
s_addc_u32 s67, s67, 2135587861
s_branch L_pollq_setup
L_np_b:
v_mov_b32 v36, -1
v_mov_b32 v37, -1
v_mov_b32 v38, -1
v_mov_b32 v39, -1
s_mul_i32 s74, s2, 4096
s_add_u32 s74, s74, 65536
s_mul_i32 s75, s2, 1792
s_add_u32 s75, s75, 1114112
buffer_store_dwordx4 v[36:39], v60, s[48:51], s74 offen sc1
buffer_store_dwordx4 v[36:39], v60, s[48:51], s74 offen offset:1024 sc1
buffer_store_dwordx4 v[36:39], v60, s[48:51], s75 offen sc1
s_mov_b32 exec_hi, 0xffff
buffer_store_dwordx4 v[36:39], v60, s[48:51], s75 offen offset:1024 sc1
s_mov_b64 exec, 1
buffer_store_dwordx4 v[36:39], v60, s[48:51], s74 offen offset:2048 sc1
s_mov_b64 exec, -1
s_waitcnt vmcnt(5)
v_readfirstlane_b32 s66, v14
v_readfirstlane_b32 s67, v15
s_nop 3
s_add_u32 s66, s66, 2654435761
s_addc_u32 s67, s67, 2135587861
v_mov_b32 v14, s66
v_mov_b32 v15, s67
L_b_ready:
v_mov_b32 v12, 0
s_lshl_b32 s42, s2, 3
s_add_u32 s42, s42, 32768
s_waitcnt vmcnt(0)
s_mov_b64 exec, 1
buffer_store_dwordx2 v[14:15], v12, s[48:51], s42 offen sc1
s_mov_b64 exec, -1
L_pollq_setup:
s_lshl_b32 s43, s4, 11
s_lshl_b32 s42, s3, 10
s_add_u32 s42, s42, s43
s_add_u32 s42, s42, 16384
s_mov_b32 s12, 0
L_pollq:
buffer_load_dwordx4 v[12:15], v60, s[48:51], s42 offen sc1
s_waitcnt vmcnt(0)
v_cmp_eq_u32 vcc, s66, v14
v_cmp_eq_u32 s[70:71], s67, v15
s_nop 3
s_and_b64 vcc, vcc, s[70:71]
s_cmp_eq_u64 vcc, -1
s_cbranch_scc1 L_pollq_done
s_add_u32 s12, s12, 1
s_cmp_lt_u32 s12, 262144
s_cbranch_scc1 L_pollq
L_pollq_done:
v_lshlrev_b32 v8, 3, v1
s_lshl_b32 s42, s3, 9
v_add_u32 v8, s42, v8
ds_write_b64 v8, v[12:13] offset:0
s_lshl_b32 s42, s3, 3
s_add_u32 s42, s42, 16896
v_mov_b32 v8, s42
v_mov_b32 v9, 0
ds_write_b32 v8, v9
s_waitcnt lgkmcnt(0)
s_barrier
s_setprio 1
s_mov_b32 s56, s16
s_mov_b32 s57, s17
s_mov_b32 s58, 896
s_mov_b32 s59, 0x20000
buffer_load_ushort v192, v61, s[56:59], 0 offen offset:0
buffer_load_ushort v193, v61, s[56:59], 0 offen offset:128
buffer_load_ushort v194, v61, s[56:59], 0 offen offset:256
buffer_load_ushort v195, v61, s[56:59], 0 offen offset:384
buffer_load_ushort v196, v61, s[56:59], 0 offen offset:512
buffer_load_ushort v197, v61, s[56:59], 0 offen offset:640
buffer_load_ushort v198, v61, s[56:59], 0 offen offset:768
s_mov_b32 s68, 99
s_cmp_eq_u32 s5, 2
s_cselect_b32 s68, 0, s68
s_cmp_eq_u32 s5, 11
s_cselect_b32 s68, 8, s68
s_cmp_eq_u32 s5, 20
s_cselect_b32 s68, 16, s68
s_cmp_eq_u32 s5, 29
s_cselect_b32 s68, 24, s68
s_add_u32 s68, s68, s4
s_cmp_lt_u32 s68, 28
s_cselect_b32 s69, 1, 0
v_mov_b32 v200, 0
v_mov_b32 v201, 0
v_mov_b32 v202, 0
v_mov_b32 v203, 0
v_mov_b32 v204, 0
v_mov_b32 v205, 0
v_mov_b32 v206, 0
v_mov_b32 v207, 0
v_mov_b32 v208, 0
v_mov_b32 v209, 0
v_mov_b32 v210, 0
v_mov_b32 v211, 0
v_mov_b32 v212, 0
v_mov_b32 v213, 0
v_mov_b32 v214, 0
v_mov_b32 v215, 0
s_cmp_eq_u32 s69, 0
s_cbranch_scc1 L_ffn_done
s_cmp_eq_u32 s3, 0
s_cselect_b32 s44, s28, s30
s_cselect_b32 s45, s29, s31
s_mov_b32 s46, 1605632
s_mov_b32 s47, 0x20000
v_bfe_u32 v8, v1, 3, 1
v_lshl_add_u32 v8, v2, 1, v8
s_mov_b32 s42, 200704
v_mul_lo_u32 v62, s42, v8
v_and_b32 v8, 7, v1
v_lshl_add_u32 v62, v8, 4, v62
v_and_b32 v8, 1, v1
v_lshl_add_u32 v8, v2, 1, v8
v_mul_u32_u24 v63, 112, v8
s_lshl_b32 s11, s68, 7
buffer_load_dwordx4 v[16:19], v63, s[56:59], 0 offen offset:0
buffer_load_dwordx4 v[20:23], v63, s[56:59], 0 offen offset:16
buffer_load_dwordx4 v[24:27], v63, s[56:59], 0 offen offset:32
buffer_load_dwordx4 v[28:31], v63, s[56:59], 0 offen offset:48
buffer_load_dwordx4 v[32:35], v63, s[56:59], 0 offen offset:64
buffer_load_dwordx4 v[36:39], v63, s[56:59], 0 offen offset:80
buffer_load_dwordx4 v[40:43], v63, s[56:59], 0 offen offset:96
v_mov_b32 v13, 0x0c0c0c0c
s_mov_b32 s42, 0x01000100
s_mov_b32 s43, 0x03020302
v_bfi_b32 v44, v4, s42, v13
v_bfi_b32 v45, v5, s42, v13
v_bfi_b32 v46, v6, s42, v13
v_bfi_b32 v47, v7, s42, v13
v_bfi_b32 v48, v4, s43, v13
v_bfi_b32 v49, v5, s43, v13
v_bfi_b32 v50, v6, s43, v13
v_bfi_b32 v51, v7, s43, v13
s_add_u32 s12, s11, 0
buffer_load_dwordx4 v[64:67], v62, s[44:47], s12 offen nt
s_add_u32 s12, s11, 3584
buffer_load_dwordx4 v[68:71], v62, s[44:47], s12 offen nt
s_add_u32 s12, s11, 7168
buffer_load_dwordx4 v[72:75], v62, s[44:47], s12 offen nt
s_add_u32 s12, s11, 10752
buffer_load_dwordx4 v[76:79], v62, s[44:47], s12 offen nt
s_add_u32 s12, s11, 14336
buffer_load_dwordx4 v[80:83], v62, s[44:47], s12 offen nt
s_add_u32 s12, s11, 17920
buffer_load_dwordx4 v[84:87], v62, s[44:47], s12 offen nt
s_add_u32 s12, s11, 21504
buffer_load_dwordx4 v[88:91], v62, s[44:47], s12 offen nt
s_add_u32 s12, s11, 25088
buffer_load_dwordx4 v[92:95], v62, s[44:47], s12 offen nt
s_add_u32 s12, s11, 28672
buffer_load_dwordx4 v[96:99], v62, s[44:47], s12 offen nt
s_add_u32 s12, s11, 32256
buffer_load_dwordx4 v[100:103], v62, s[44:47], s12 offen nt
s_add_u32 s12, s11, 35840
buffer_load_dwordx4 v[104:107], v62, s[44:47], s12 offen nt
s_add_u32 s12, s11, 39424
buffer_load_dwordx4 v[108:111], v62, s[44:47], s12 offen nt
s_add_u32 s12, s11, 43008
buffer_load_dwordx4 v[112:115], v62, s[44:47], s12 offen nt
s_add_u32 s12, s11, 46592
buffer_load_dwordx4 v[116:119], v62, s[44:47], s12 offen nt
s_add_u32 s12, s11, 50176
buffer_load_dwordx4 v[120:123], v62, s[44:47], s12 offen nt
s_add_u32 s12, s11, 53760
buffer_load_dwordx4 v[124:127], v62, s[44:47], s12 offen nt
s_add_u32 s12, s11, 57344
buffer_load_dwordx4 v[128:131], v62, s[44:47], s12 offen nt
s_add_u32 s12, s11, 60928
buffer_load_dwordx4 v[132:135], v62, s[44:47], s12 offen nt
s_add_u32 s12, s11, 64512
buffer_load_dwordx4 v[136:139], v62, s[44:47], s12 offen nt
s_add_u32 s12, s11, 68096
buffer_load_dwordx4 v[140:143], v62, s[44:47], s12 offen nt
s_add_u32 s12, s11, 71680
buffer_load_dwordx4 v[144:147], v62, s[44:47], s12 offen nt
s_add_u32 s12, s11, 75264
buffer_load_dwordx4 v[148:151], v62, s[44:47], s12 offen nt
s_add_u32 s12, s11, 78848
buffer_load_dwordx4 v[152:155], v62, s[44:47], s12 offen nt
s_add_u32 s12, s11, 82432
buffer_load_dwordx4 v[156:159], v62, s[44:47], s12 offen nt
s_add_u32 s12, s11, 86016
buffer_load_dwordx4 v[160:163], v62, s[44:47], s12 offen nt
s_add_u32 s12, s11, 89600
buffer_load_dwordx4 v[164:167], v62, s[44:47], s12 offen nt
s_add_u32 s12, s11, 93184
buffer_load_dwordx4 v[168:171], v62, s[44:47], s12 offen nt
s_add_u32 s12, s11, 96768
buffer_load_dwordx4 v[172:175], v62, s[44:47], s12 offen nt
s_waitcnt vmcnt(28)
v_perm_b32 v52, v16, v16, v44
v_perm_b32 v53, v16, v16, v45
v_perm_b32 v54, v16, v16, v46
v_perm_b32 v55, v16, v16, v47
v_perm_b32 v56, v16, v16, v48
v_perm_b32 v57, v16, v16, v49
v_perm_b32 v58, v16, v16, v50
v_perm_b32 v59, v16, v16, v51
s_waitcnt vmcnt(27)
v_mfma_f32_16x16x32_bf16 v[8:11], v[52:55], v[64:67], 0
v_perm_b32 v52, v17, v17, v44
v_perm_b32 v53, v17, v17, v45
v_perm_b32 v54, v17, v17, v46
v_perm_b32 v55, v17, v17, v47
s_waitcnt vmcnt(26)
v_mfma_f32_16x16x32_bf16 v[8:11], v[56:59], v[68:71], v[8:11]
v_perm_b32 v56, v17, v17, v48
v_perm_b32 v57, v17, v17, v49
v_perm_b32 v58, v17, v17, v50
v_perm_b32 v59, v17, v17, v51
s_waitcnt vmcnt(25)
v_mfma_f32_16x16x32_bf16 v[8:11], v[52:55], v[72:75], v[8:11]
v_perm_b32 v52, v18, v18, v44
v_perm_b32 v53, v18, v18, v45
v_perm_b32 v54, v18, v18, v46
v_perm_b32 v55, v18, v18, v47
s_waitcnt vmcnt(24)
v_mfma_f32_16x16x32_bf16 v[8:11], v[56:59], v[76:79], v[8:11]
v_perm_b32 v56, v18, v18, v48
v_perm_b32 v57, v18, v18, v49
v_perm_b32 v58, v18, v18, v50
v_perm_b32 v59, v18, v18, v51
s_waitcnt vmcnt(23)
v_mfma_f32_16x16x32_bf16 v[8:11], v[52:55], v[80:83], v[8:11]
v_perm_b32 v52, v19, v19, v44
v_perm_b32 v53, v19, v19, v45
v_perm_b32 v54, v19, v19, v46
v_perm_b32 v55, v19, v19, v47
s_waitcnt vmcnt(22)
v_mfma_f32_16x16x32_bf16 v[8:11], v[56:59], v[84:87], v[8:11]
v_perm_b32 v56, v19, v19, v48
v_perm_b32 v57, v19, v19, v49
v_perm_b32 v58, v19, v19, v50
v_perm_b32 v59, v19, v19, v51
s_waitcnt vmcnt(21)
v_mfma_f32_16x16x32_bf16 v[8:11], v[52:55], v[88:91], v[8:11]
v_perm_b32 v52, v20, v20, v44
v_perm_b32 v53, v20, v20, v45
v_perm_b32 v54, v20, v20, v46
v_perm_b32 v55, v20, v20, v47
s_waitcnt vmcnt(20)
v_mfma_f32_16x16x32_bf16 v[8:11], v[56:59], v[92:95], v[8:11]
v_perm_b32 v56, v20, v20, v48
v_perm_b32 v57, v20, v20, v49
v_perm_b32 v58, v20, v20, v50
v_perm_b32 v59, v20, v20, v51
s_waitcnt vmcnt(19)
v_mfma_f32_16x16x32_bf16 v[8:11], v[52:55], v[96:99], v[8:11]
v_perm_b32 v52, v21, v21, v44
v_perm_b32 v53, v21, v21, v45
v_perm_b32 v54, v21, v21, v46
v_perm_b32 v55, v21, v21, v47
s_waitcnt vmcnt(18)
v_mfma_f32_16x16x32_bf16 v[8:11], v[56:59], v[100:103], v[8:11]
v_perm_b32 v56, v21, v21, v48
v_perm_b32 v57, v21, v21, v49
v_perm_b32 v58, v21, v21, v50
v_perm_b32 v59, v21, v21, v51
s_waitcnt vmcnt(17)
v_mfma_f32_16x16x32_bf16 v[8:11], v[52:55], v[104:107], v[8:11]
v_perm_b32 v52, v22, v22, v44
v_perm_b32 v53, v22, v22, v45
v_perm_b32 v54, v22, v22, v46
v_perm_b32 v55, v22, v22, v47
s_waitcnt vmcnt(16)
v_mfma_f32_16x16x32_bf16 v[8:11], v[56:59], v[108:111], v[8:11]
v_perm_b32 v56, v22, v22, v48
v_perm_b32 v57, v22, v22, v49
v_perm_b32 v58, v22, v22, v50
v_perm_b32 v59, v22, v22, v51
s_waitcnt vmcnt(15)
v_mfma_f32_16x16x32_bf16 v[8:11], v[52:55], v[112:115], v[8:11]
v_perm_b32 v52, v23, v23, v44
v_perm_b32 v53, v23, v23, v45
v_perm_b32 v54, v23, v23, v46
v_perm_b32 v55, v23, v23, v47
s_waitcnt vmcnt(14)
v_mfma_f32_16x16x32_bf16 v[8:11], v[56:59], v[116:119], v[8:11]
v_perm_b32 v56, v23, v23, v48
v_perm_b32 v57, v23, v23, v49
v_perm_b32 v58, v23, v23, v50
v_perm_b32 v59, v23, v23, v51
s_waitcnt vmcnt(13)
v_mfma_f32_16x16x32_bf16 v[8:11], v[52:55], v[120:123], v[8:11]
v_perm_b32 v52, v24, v24, v44
v_perm_b32 v53, v24, v24, v45
v_perm_b32 v54, v24, v24, v46
v_perm_b32 v55, v24, v24, v47
s_waitcnt vmcnt(12)
v_mfma_f32_16x16x32_bf16 v[8:11], v[56:59], v[124:127], v[8:11]
v_perm_b32 v56, v24, v24, v48
v_perm_b32 v57, v24, v24, v49
v_perm_b32 v58, v24, v24, v50
v_perm_b32 v59, v24, v24, v51
s_waitcnt vmcnt(11)
v_mfma_f32_16x16x32_bf16 v[8:11], v[52:55], v[128:131], v[8:11]
v_perm_b32 v52, v25, v25, v44
v_perm_b32 v53, v25, v25, v45
v_perm_b32 v54, v25, v25, v46
v_perm_b32 v55, v25, v25, v47
s_waitcnt vmcnt(10)
v_mfma_f32_16x16x32_bf16 v[8:11], v[56:59], v[132:135], v[8:11]
v_perm_b32 v56, v25, v25, v48
v_perm_b32 v57, v25, v25, v49
v_perm_b32 v58, v25, v25, v50
v_perm_b32 v59, v25, v25, v51
s_waitcnt vmcnt(9)
v_mfma_f32_16x16x32_bf16 v[8:11], v[52:55], v[136:139], v[8:11]
v_perm_b32 v52, v26, v26, v44
v_perm_b32 v53, v26, v26, v45
v_perm_b32 v54, v26, v26, v46
v_perm_b32 v55, v26, v26, v47
s_waitcnt vmcnt(8)
v_mfma_f32_16x16x32_bf16 v[8:11], v[56:59], v[140:143], v[8:11]
v_perm_b32 v56, v26, v26, v48
v_perm_b32 v57, v26, v26, v49
v_perm_b32 v58, v26, v26, v50
v_perm_b32 v59, v26, v26, v51
s_waitcnt vmcnt(7)
v_mfma_f32_16x16x32_bf16 v[8:11], v[52:55], v[144:147], v[8:11]
v_perm_b32 v52, v27, v27, v44
v_perm_b32 v53, v27, v27, v45
v_perm_b32 v54, v27, v27, v46
v_perm_b32 v55, v27, v27, v47
s_waitcnt vmcnt(6)
v_mfma_f32_16x16x32_bf16 v[8:11], v[56:59], v[148:151], v[8:11]
v_perm_b32 v56, v27, v27, v48
v_perm_b32 v57, v27, v27, v49
v_perm_b32 v58, v27, v27, v50
v_perm_b32 v59, v27, v27, v51
s_waitcnt vmcnt(5)
v_mfma_f32_16x16x32_bf16 v[8:11], v[52:55], v[152:155], v[8:11]
v_perm_b32 v52, v28, v28, v44
v_perm_b32 v53, v28, v28, v45
v_perm_b32 v54, v28, v28, v46
v_perm_b32 v55, v28, v28, v47
s_waitcnt vmcnt(4)
v_mfma_f32_16x16x32_bf16 v[8:11], v[56:59], v[156:159], v[8:11]
v_perm_b32 v56, v28, v28, v48
v_perm_b32 v57, v28, v28, v49
v_perm_b32 v58, v28, v28, v50
v_perm_b32 v59, v28, v28, v51
s_waitcnt vmcnt(3)
v_mfma_f32_16x16x32_bf16 v[8:11], v[52:55], v[160:163], v[8:11]
v_perm_b32 v52, v29, v29, v44
v_perm_b32 v53, v29, v29, v45
v_perm_b32 v54, v29, v29, v46
v_perm_b32 v55, v29, v29, v47
s_waitcnt vmcnt(2)
v_mfma_f32_16x16x32_bf16 v[8:11], v[56:59], v[164:167], v[8:11]
v_perm_b32 v56, v29, v29, v48
v_perm_b32 v57, v29, v29, v49
v_perm_b32 v58, v29, v29, v50
v_perm_b32 v59, v29, v29, v51
s_waitcnt vmcnt(1)
v_mfma_f32_16x16x32_bf16 v[8:11], v[52:55], v[168:171], v[8:11]
s_waitcnt vmcnt(0)
v_mfma_f32_16x16x32_bf16 v[8:11], v[56:59], v[172:175], v[8:11]
s_add_u32 s12, s11, 100352
buffer_load_dwordx4 v[64:67], v62, s[44:47], s12 offen nt
s_add_u32 s12, s11, 103936
buffer_load_dwordx4 v[68:71], v62, s[44:47], s12 offen nt
s_add_u32 s12, s11, 107520
buffer_load_dwordx4 v[72:75], v62, s[44:47], s12 offen nt
s_add_u32 s12, s11, 111104
buffer_load_dwordx4 v[76:79], v62, s[44:47], s12 offen nt
s_add_u32 s12, s11, 114688
buffer_load_dwordx4 v[80:83], v62, s[44:47], s12 offen nt
s_add_u32 s12, s11, 118272
buffer_load_dwordx4 v[84:87], v62, s[44:47], s12 offen nt
s_add_u32 s12, s11, 121856
buffer_load_dwordx4 v[88:91], v62, s[44:47], s12 offen nt
s_add_u32 s12, s11, 125440
buffer_load_dwordx4 v[92:95], v62, s[44:47], s12 offen nt
s_add_u32 s12, s11, 129024
buffer_load_dwordx4 v[96:99], v62, s[44:47], s12 offen nt
s_add_u32 s12, s11, 132608
buffer_load_dwordx4 v[100:103], v62, s[44:47], s12 offen nt
s_add_u32 s12, s11, 136192
buffer_load_dwordx4 v[104:107], v62, s[44:47], s12 offen nt
s_add_u32 s12, s11, 139776
buffer_load_dwordx4 v[108:111], v62, s[44:47], s12 offen nt
s_add_u32 s12, s11, 143360
buffer_load_dwordx4 v[112:115], v62, s[44:47], s12 offen nt
s_add_u32 s12, s11, 146944
buffer_load_dwordx4 v[116:119], v62, s[44:47], s12 offen nt
s_add_u32 s12, s11, 150528
buffer_load_dwordx4 v[120:123], v62, s[44:47], s12 offen nt
s_add_u32 s12, s11, 154112
buffer_load_dwordx4 v[124:127], v62, s[44:47], s12 offen nt
s_add_u32 s12, s11, 157696
buffer_load_dwordx4 v[128:131], v62, s[44:47], s12 offen nt
s_add_u32 s12, s11, 161280
buffer_load_dwordx4 v[132:135], v62, s[44:47], s12 offen nt
s_add_u32 s12, s11, 164864
buffer_load_dwordx4 v[136:139], v62, s[44:47], s12 offen nt
s_add_u32 s12, s11, 168448
buffer_load_dwordx4 v[140:143], v62, s[44:47], s12 offen nt
s_add_u32 s12, s11, 172032
buffer_load_dwordx4 v[144:147], v62, s[44:47], s12 offen nt
s_add_u32 s12, s11, 175616
buffer_load_dwordx4 v[148:151], v62, s[44:47], s12 offen nt
s_add_u32 s12, s11, 179200
buffer_load_dwordx4 v[152:155], v62, s[44:47], s12 offen nt
s_add_u32 s12, s11, 182784
buffer_load_dwordx4 v[156:159], v62, s[44:47], s12 offen nt
s_add_u32 s12, s11, 186368
buffer_load_dwordx4 v[160:163], v62, s[44:47], s12 offen nt
s_add_u32 s12, s11, 189952
buffer_load_dwordx4 v[164:167], v62, s[44:47], s12 offen nt
s_add_u32 s12, s11, 193536
buffer_load_dwordx4 v[168:171], v62, s[44:47], s12 offen nt
s_add_u32 s12, s11, 197120
buffer_load_dwordx4 v[172:175], v62, s[44:47], s12 offen nt
v_perm_b32 v52, v30, v30, v44
v_perm_b32 v53, v30, v30, v45
v_perm_b32 v54, v30, v30, v46
v_perm_b32 v55, v30, v30, v47
v_perm_b32 v56, v30, v30, v48
v_perm_b32 v57, v30, v30, v49
v_perm_b32 v58, v30, v30, v50
v_perm_b32 v59, v30, v30, v51
s_waitcnt vmcnt(27)
v_mfma_f32_16x16x32_bf16 v[8:11], v[52:55], v[64:67], v[8:11]
v_perm_b32 v52, v31, v31, v44
v_perm_b32 v53, v31, v31, v45
v_perm_b32 v54, v31, v31, v46
v_perm_b32 v55, v31, v31, v47
s_waitcnt vmcnt(26)
v_mfma_f32_16x16x32_bf16 v[8:11], v[56:59], v[68:71], v[8:11]
v_perm_b32 v56, v31, v31, v48
v_perm_b32 v57, v31, v31, v49
v_perm_b32 v58, v31, v31, v50
v_perm_b32 v59, v31, v31, v51
s_waitcnt vmcnt(25)
v_mfma_f32_16x16x32_bf16 v[8:11], v[52:55], v[72:75], v[8:11]
v_perm_b32 v52, v32, v32, v44
v_perm_b32 v53, v32, v32, v45
v_perm_b32 v54, v32, v32, v46
v_perm_b32 v55, v32, v32, v47
s_waitcnt vmcnt(24)
v_mfma_f32_16x16x32_bf16 v[8:11], v[56:59], v[76:79], v[8:11]
v_perm_b32 v56, v32, v32, v48
v_perm_b32 v57, v32, v32, v49
v_perm_b32 v58, v32, v32, v50
v_perm_b32 v59, v32, v32, v51
s_waitcnt vmcnt(23)
v_mfma_f32_16x16x32_bf16 v[8:11], v[52:55], v[80:83], v[8:11]
v_perm_b32 v52, v33, v33, v44
v_perm_b32 v53, v33, v33, v45
v_perm_b32 v54, v33, v33, v46
v_perm_b32 v55, v33, v33, v47
s_waitcnt vmcnt(22)
v_mfma_f32_16x16x32_bf16 v[8:11], v[56:59], v[84:87], v[8:11]
v_perm_b32 v56, v33, v33, v48
v_perm_b32 v57, v33, v33, v49
v_perm_b32 v58, v33, v33, v50
v_perm_b32 v59, v33, v33, v51
s_waitcnt vmcnt(21)
v_mfma_f32_16x16x32_bf16 v[8:11], v[52:55], v[88:91], v[8:11]
v_perm_b32 v52, v34, v34, v44
v_perm_b32 v53, v34, v34, v45
v_perm_b32 v54, v34, v34, v46
v_perm_b32 v55, v34, v34, v47
s_waitcnt vmcnt(20)
v_mfma_f32_16x16x32_bf16 v[8:11], v[56:59], v[92:95], v[8:11]
v_perm_b32 v56, v34, v34, v48
v_perm_b32 v57, v34, v34, v49
v_perm_b32 v58, v34, v34, v50
v_perm_b32 v59, v34, v34, v51
s_waitcnt vmcnt(19)
v_mfma_f32_16x16x32_bf16 v[8:11], v[52:55], v[96:99], v[8:11]
v_perm_b32 v52, v35, v35, v44
v_perm_b32 v53, v35, v35, v45
v_perm_b32 v54, v35, v35, v46
v_perm_b32 v55, v35, v35, v47
s_waitcnt vmcnt(18)
v_mfma_f32_16x16x32_bf16 v[8:11], v[56:59], v[100:103], v[8:11]
v_perm_b32 v56, v35, v35, v48
v_perm_b32 v57, v35, v35, v49
v_perm_b32 v58, v35, v35, v50
v_perm_b32 v59, v35, v35, v51
s_waitcnt vmcnt(17)
v_mfma_f32_16x16x32_bf16 v[8:11], v[52:55], v[104:107], v[8:11]
v_perm_b32 v52, v36, v36, v44
v_perm_b32 v53, v36, v36, v45
v_perm_b32 v54, v36, v36, v46
v_perm_b32 v55, v36, v36, v47
s_waitcnt vmcnt(16)
v_mfma_f32_16x16x32_bf16 v[8:11], v[56:59], v[108:111], v[8:11]
v_perm_b32 v56, v36, v36, v48
v_perm_b32 v57, v36, v36, v49
v_perm_b32 v58, v36, v36, v50
v_perm_b32 v59, v36, v36, v51
s_waitcnt vmcnt(15)
v_mfma_f32_16x16x32_bf16 v[8:11], v[52:55], v[112:115], v[8:11]
v_perm_b32 v52, v37, v37, v44
v_perm_b32 v53, v37, v37, v45
v_perm_b32 v54, v37, v37, v46
v_perm_b32 v55, v37, v37, v47
s_waitcnt vmcnt(14)
v_mfma_f32_16x16x32_bf16 v[8:11], v[56:59], v[116:119], v[8:11]
v_perm_b32 v56, v37, v37, v48
v_perm_b32 v57, v37, v37, v49
v_perm_b32 v58, v37, v37, v50
v_perm_b32 v59, v37, v37, v51
s_waitcnt vmcnt(13)
v_mfma_f32_16x16x32_bf16 v[8:11], v[52:55], v[120:123], v[8:11]
v_perm_b32 v52, v38, v38, v44
v_perm_b32 v53, v38, v38, v45
v_perm_b32 v54, v38, v38, v46
v_perm_b32 v55, v38, v38, v47
s_waitcnt vmcnt(12)
v_mfma_f32_16x16x32_bf16 v[8:11], v[56:59], v[124:127], v[8:11]
v_perm_b32 v56, v38, v38, v48
v_perm_b32 v57, v38, v38, v49
v_perm_b32 v58, v38, v38, v50
v_perm_b32 v59, v38, v38, v51
s_waitcnt vmcnt(11)
v_mfma_f32_16x16x32_bf16 v[8:11], v[52:55], v[128:131], v[8:11]
v_perm_b32 v52, v39, v39, v44
v_perm_b32 v53, v39, v39, v45
v_perm_b32 v54, v39, v39, v46
v_perm_b32 v55, v39, v39, v47
s_waitcnt vmcnt(10)
v_mfma_f32_16x16x32_bf16 v[8:11], v[56:59], v[132:135], v[8:11]
v_perm_b32 v56, v39, v39, v48
v_perm_b32 v57, v39, v39, v49
v_perm_b32 v58, v39, v39, v50
v_perm_b32 v59, v39, v39, v51
s_waitcnt vmcnt(9)
v_mfma_f32_16x16x32_bf16 v[8:11], v[52:55], v[136:139], v[8:11]
v_perm_b32 v52, v40, v40, v44
v_perm_b32 v53, v40, v40, v45
v_perm_b32 v54, v40, v40, v46
v_perm_b32 v55, v40, v40, v47
s_waitcnt vmcnt(8)
v_mfma_f32_16x16x32_bf16 v[8:11], v[56:59], v[140:143], v[8:11]
v_perm_b32 v56, v40, v40, v48
v_perm_b32 v57, v40, v40, v49
v_perm_b32 v58, v40, v40, v50
v_perm_b32 v59, v40, v40, v51
s_waitcnt vmcnt(7)
v_mfma_f32_16x16x32_bf16 v[8:11], v[52:55], v[144:147], v[8:11]
v_perm_b32 v52, v41, v41, v44
v_perm_b32 v53, v41, v41, v45
v_perm_b32 v54, v41, v41, v46
v_perm_b32 v55, v41, v41, v47
s_waitcnt vmcnt(6)
v_mfma_f32_16x16x32_bf16 v[8:11], v[56:59], v[148:151], v[8:11]
v_perm_b32 v56, v41, v41, v48
v_perm_b32 v57, v41, v41, v49
v_perm_b32 v58, v41, v41, v50
v_perm_b32 v59, v41, v41, v51
s_waitcnt vmcnt(5)
v_mfma_f32_16x16x32_bf16 v[8:11], v[52:55], v[152:155], v[8:11]
v_perm_b32 v52, v42, v42, v44
v_perm_b32 v53, v42, v42, v45
v_perm_b32 v54, v42, v42, v46
v_perm_b32 v55, v42, v42, v47
s_waitcnt vmcnt(4)
v_mfma_f32_16x16x32_bf16 v[8:11], v[56:59], v[156:159], v[8:11]
v_perm_b32 v56, v42, v42, v48
v_perm_b32 v57, v42, v42, v49
v_perm_b32 v58, v42, v42, v50
v_perm_b32 v59, v42, v42, v51
s_waitcnt vmcnt(3)
v_mfma_f32_16x16x32_bf16 v[8:11], v[52:55], v[160:163], v[8:11]
v_perm_b32 v52, v43, v43, v44
v_perm_b32 v53, v43, v43, v45
v_perm_b32 v54, v43, v43, v46
v_perm_b32 v55, v43, v43, v47
s_waitcnt vmcnt(2)
v_mfma_f32_16x16x32_bf16 v[8:11], v[56:59], v[164:167], v[8:11]
v_perm_b32 v56, v43, v43, v48
v_perm_b32 v57, v43, v43, v49
v_perm_b32 v58, v43, v43, v50
v_perm_b32 v59, v43, v43, v51
s_waitcnt vmcnt(1)
v_mfma_f32_16x16x32_bf16 v[8:11], v[52:55], v[168:171], v[8:11]
s_waitcnt vmcnt(0)
v_mfma_f32_16x16x32_bf16 v[8:11], v[56:59], v[172:175], v[8:11]
s_mov_b32 s44, s32
s_mov_b32 s45, s33
s_mov_b32 s46, 1605632
s_mov_b32 s47, 0x20000
s_mov_b32 s42, 3584
v_mul_lo_u32 v45, s42, v2
v_lshl_add_u32 v45, v3, 4, v45
s_lshl_b32 s10, s68, 6
s_lshl_b32 s42, s3, 5
s_add_u32 s10, s10, s42
s_mul_i32 s10, s10, 896
s_add_u32 s13, s10, 14336
buffer_load_dwordx4 v[64:67], v45, s[44:47], s10 offen offset:0 nt
buffer_load_dwordx4 v[68:71], v45, s[44:47], s10 offen offset:256 nt
buffer_load_dwordx4 v[72:75], v45, s[44:47], s10 offen offset:512 nt
buffer_load_dwordx4 v[76:79], v45, s[44:47], s10 offen offset:768 nt
buffer_load_dwordx4 v[80:83], v45, s[44:47], s10 offen offset:896 nt
buffer_load_dwordx4 v[84:87], v45, s[44:47], s10 offen offset:1152 nt
buffer_load_dwordx4 v[88:91], v45, s[44:47], s10 offen offset:1408 nt
buffer_load_dwordx4 v[92:95], v45, s[44:47], s10 offen offset:1664 nt
buffer_load_dwordx4 v[96:99], v45, s[44:47], s10 offen offset:1792 nt
buffer_load_dwordx4 v[100:103], v45, s[44:47], s10 offen offset:2048 nt
buffer_load_dwordx4 v[104:107], v45, s[44:47], s10 offen offset:2304 nt
buffer_load_dwordx4 v[108:111], v45, s[44:47], s10 offen offset:2560 nt
buffer_load_dwordx4 v[112:115], v45, s[44:47], s10 offen offset:2688 nt
buffer_load_dwordx4 v[116:119], v45, s[44:47], s10 offen offset:2944 nt
buffer_load_dwordx4 v[120:123], v45, s[44:47], s10 offen offset:3200 nt
buffer_load_dwordx4 v[124:127], v45, s[44:47], s10 offen offset:3456 nt
buffer_load_dwordx4 v[128:131], v45, s[44:47], s13 offen offset:0 nt
buffer_load_dwordx4 v[132:135], v45, s[44:47], s13 offen offset:256 nt
buffer_load_dwordx4 v[136:139], v45, s[44:47], s13 offen offset:512 nt
buffer_load_dwordx4 v[140:143], v45, s[44:47], s13 offen offset:768 nt
buffer_load_dwordx4 v[144:147], v45, s[44:47], s13 offen offset:896 nt
buffer_load_dwordx4 v[148:151], v45, s[44:47], s13 offen offset:1152 nt
buffer_load_dwordx4 v[152:155], v45, s[44:47], s13 offen offset:1408 nt
buffer_load_dwordx4 v[156:159], v45, s[44:47], s13 offen offset:1664 nt
buffer_load_dwordx4 v[160:163], v45, s[44:47], s13 offen offset:1792 nt
buffer_load_dwordx4 v[164:167], v45, s[44:47], s13 offen offset:2048 nt
buffer_load_dwordx4 v[168:171], v45, s[44:47], s13 offen offset:2304 nt
buffer_load_dwordx4 v[172:175], v45, s[44:47], s13 offen offset:2560 nt
buffer_load_dwordx4 v[176:179], v45, s[44:47], s13 offen offset:2688 nt
buffer_load_dwordx4 v[180:183], v45, s[44:47], s13 offen offset:2944 nt
buffer_load_dwordx4 v[184:187], v45, s[44:47], s13 offen offset:3200 nt
buffer_load_dwordx4 v[188:191], v45, s[44:47], s13 offen offset:3456 nt
v_add_f32_dpp v8, v9, v8 row_ror:8 row_mask:0xf bank_mask:0xf
v_add_f32_dpp v10, v11, v10 row_ror:8 row_mask:0xf bank_mask:0xf
s_nop 0
v_cvt_pk_bf16_f32 v12, v8, v10
v_lshlrev_b32 v10, 16, v12
v_and_b32 v11, 0xffff0000, v12
v_and_b32 v8, 7, v1
v_lshlrev_b32 v8, 5, v8
v_lshl_add_u32 v8, v2, 3, v8
s_lshl_b32 s42, s3, 8
v_add_u32 v8, s42, v8
s_mov_b32 exec_lo, 0x00ff00ff
s_mov_b32 exec_hi, 0x00ff00ff
ds_write_b64 v8, v[10:11] offset:16384
s_mov_b64 exec, -1
s_waitcnt lgkmcnt(0)
v_mov_b32 v14, 1
s_lshl_b32 s42, s3, 3
s_add_u32 s42, s42, 16896
v_mov_b32 v16, s42
s_xor_b32 s42, s42, 8
v_mov_b32 v17, s42
s_mov_b64 exec, 1
ds_write_b32 v16, v14
s_mov_b64 exec, -1
s_mov_b32 s12, 0
L_f_wait:
ds_read_b32 v18, v17
s_waitcnt lgkmcnt(0)
v_cmp_eq_u32 vcc, 1, v18
s_nop 1
s_cmp_eq_u64 vcc, -1
s_cbranch_scc1 L_f_got
s_sleep 2
s_add_u32 s12, s12, 1
s_cmp_lt_u32 s12, 1048576
s_cbranch_scc1 L_f_wait
L_f_got:
v_lshlrev_b32 v8, 4, v2
s_lshl_b32 s42, s3, 7
v_add_u32 v8, s42, v8
ds_read_b128 v[16:19], v8 offset:16384
ds_read_b128 v[20:23], v8 offset:16448
ds_read_b128 v[24:27], v8 offset:16640
ds_read_b128 v[28:31], v8 offset:16704
s_waitcnt lgkmcnt(0)
v_max_f32 v16, 0, v16
v_max_f32 v17, 0, v17
v_max_f32 v18, 0, v18
v_max_f32 v19, 0, v19
v_max_f32 v20, 0, v20
v_max_f32 v21, 0, v21
v_max_f32 v22, 0, v22
v_max_f32 v23, 0, v23
v_mul_f32 v16, v16, v24
v_mul_f32 v17, v17, v25
v_mul_f32 v18, v18, v26
v_mul_f32 v19, v19, v27
v_mul_f32 v20, v20, v28
v_mul_f32 v21, v21, v29
v_mul_f32 v22, v22, v30
v_mul_f32 v23, v23, v31
v_cvt_pk_bf16_f32 v16, v16, v16
v_cvt_pk_bf16_f32 v17, v17, v17
v_cvt_pk_bf16_f32 v18, v18, v18
v_cvt_pk_bf16_f32 v19, v19, v19
v_cvt_pk_bf16_f32 v20, v20, v20
v_cvt_pk_bf16_f32 v21, v21, v21
v_cvt_pk_bf16_f32 v22, v22, v22
v_cvt_pk_bf16_f32 v23, v23, v23
v_and_b32 v32, v16, v4
v_and_b32 v33, v16, v5
v_and_b32 v34, v16, v6
v_and_b32 v35, v16, v7
s_waitcnt vmcnt(0)
s_nop 0
v_mfma_f32_16x16x32_bf16 v[200:203], v[32:35], v[64:67], v[200:203]
v_mfma_f32_16x16x32_bf16 v[204:207], v[32:35], v[68:71], v[204:207]
v_mfma_f32_16x16x32_bf16 v[208:211], v[32:35], v[72:75], v[208:211]
v_mfma_f32_16x16x32_bf16 v[212:215], v[32:35], v[76:79], v[212:215]
v_and_b32 v36, v17, v4
v_and_b32 v37, v17, v5
v_and_b32 v38, v17, v6
v_and_b32 v39, v17, v7
s_nop 1
v_mfma_f32_16x16x32_bf16 v[200:203], v[36:39], v[80:83], v[200:203]
v_mfma_f32_16x16x32_bf16 v[204:207], v[36:39], v[84:87], v[204:207]
v_mfma_f32_16x16x32_bf16 v[208:211], v[36:39], v[88:91], v[208:211]
v_mfma_f32_16x16x32_bf16 v[212:215], v[36:39], v[92:95], v[212:215]
v_and_b32 v32, v18, v4
v_and_b32 v33, v18, v5
v_and_b32 v34, v18, v6
v_and_b32 v35, v18, v7
s_nop 1
v_mfma_f32_16x16x32_bf16 v[200:203], v[32:35], v[96:99], v[200:203]
v_mfma_f32_16x16x32_bf16 v[204:207], v[32:35], v[100:103], v[204:207]
v_mfma_f32_16x16x32_bf16 v[208:211], v[32:35], v[104:107], v[208:211]
v_mfma_f32_16x16x32_bf16 v[212:215], v[32:35], v[108:111], v[212:215]
v_and_b32 v36, v19, v4
v_and_b32 v37, v19, v5
v_and_b32 v38, v19, v6
v_and_b32 v39, v19, v7
s_nop 1
v_mfma_f32_16x16x32_bf16 v[200:203], v[36:39], v[112:115], v[200:203]
v_mfma_f32_16x16x32_bf16 v[204:207], v[36:39], v[116:119], v[204:207]
v_mfma_f32_16x16x32_bf16 v[208:211], v[36:39], v[120:123], v[208:211]
v_mfma_f32_16x16x32_bf16 v[212:215], v[36:39], v[124:127], v[212:215]
v_and_b32 v32, v20, v4
v_and_b32 v33, v20, v5
v_and_b32 v34, v20, v6
v_and_b32 v35, v20, v7
s_nop 1
v_mfma_f32_16x16x32_bf16 v[200:203], v[32:35], v[128:131], v[200:203]
v_mfma_f32_16x16x32_bf16 v[204:207], v[32:35], v[132:135], v[204:207]
v_mfma_f32_16x16x32_bf16 v[208:211], v[32:35], v[136:139], v[208:211]
v_mfma_f32_16x16x32_bf16 v[212:215], v[32:35], v[140:143], v[212:215]
v_and_b32 v36, v21, v4
v_and_b32 v37, v21, v5
v_and_b32 v38, v21, v6
v_and_b32 v39, v21, v7
s_nop 1
v_mfma_f32_16x16x32_bf16 v[200:203], v[36:39], v[144:147], v[200:203]
v_mfma_f32_16x16x32_bf16 v[204:207], v[36:39], v[148:151], v[204:207]
v_mfma_f32_16x16x32_bf16 v[208:211], v[36:39], v[152:155], v[208:211]
v_mfma_f32_16x16x32_bf16 v[212:215], v[36:39], v[156:159], v[212:215]
v_and_b32 v32, v22, v4
v_and_b32 v33, v22, v5
v_and_b32 v34, v22, v6
v_and_b32 v35, v22, v7
s_nop 1
v_mfma_f32_16x16x32_bf16 v[200:203], v[32:35], v[160:163], v[200:203]
v_mfma_f32_16x16x32_bf16 v[204:207], v[32:35], v[164:167], v[204:207]
v_mfma_f32_16x16x32_bf16 v[208:211], v[32:35], v[168:171], v[208:211]
v_mfma_f32_16x16x32_bf16 v[212:215], v[32:35], v[172:175], v[212:215]
v_and_b32 v36, v23, v4
v_and_b32 v37, v23, v5
v_and_b32 v38, v23, v6
v_and_b32 v39, v23, v7
s_nop 1
v_mfma_f32_16x16x32_bf16 v[200:203], v[36:39], v[176:179], v[200:203]
v_mfma_f32_16x16x32_bf16 v[204:207], v[36:39], v[180:183], v[204:207]
v_mfma_f32_16x16x32_bf16 v[208:211], v[36:39], v[184:187], v[208:211]
v_mfma_f32_16x16x32_bf16 v[212:215], v[36:39], v[188:191], v[212:215]
s_nop 7
s_nop 3
L_ffn_done:
v_lshlrev_b32 v8, 5, v3
v_lshl_add_u32 v8, v2, 3, v8
s_lshl_b32 s42, s3, 11
v_add_u32 v8, s42, v8
v_mov_b32 v201, v202
v_mov_b32 v205, v206
v_mov_b32 v209, v210
v_mov_b32 v213, v214
ds_write_b64 v8, v[200:201] offset:2048
ds_write_b64 v8, v[204:205] offset:2560
ds_write_b64 v8, v[208:209] offset:3072
ds_write_b64 v8, v[212:213] offset:3584
s_waitcnt vmcnt(0)
v_lshlrev_b32 v192, 16, v192
v_lshlrev_b32 v193, 16, v193
v_lshlrev_b32 v194, 16, v194
v_lshlrev_b32 v195, 16, v195
v_lshlrev_b32 v196, 16, v196
v_lshlrev_b32 v197, 16, v197
v_lshlrev_b32 v198, 16, v198
s_waitcnt lgkmcnt(0)
s_cmp_eq_u32 s3, 0
s_cbranch_scc0 L_svc_b1
s_mov_b32 s44, s24
s_mov_b32 s45, s25
s_mov_b32 s46, 3670016
s_mov_b32 s47, 0x20000
s_mov_b32 s42, 3584
v_mul_lo_u32 v9, s42, v2
v_lshl_add_u32 v9, v3, 4, v9
s_lshl_b32 s10, s4, 9
s_lshl_b32 s42, s5, 4
s_add_u32 s10, s10, s42
s_mul_i32 s10, s10, 896
s_mov_b32 s52, s34
s_mov_b32 s53, s35
s_mov_b32 s54, 896
s_mov_b32 s55, 0x20000
buffer_load_ushort v24, v61, s[52:55], 0 offen offset:0
buffer_load_ushort v25, v61, s[52:55], 0 offen offset:128
buffer_load_ushort v26, v61, s[52:55], 0 offen offset:256
buffer_load_ushort v27, v61, s[52:55], 0 offen offset:384
buffer_load_ushort v28, v61, s[52:55], 0 offen offset:512
buffer_load_ushort v29, v61, s[52:55], 0 offen offset:640
buffer_load_ushort v30, v61, s[52:55], 0 offen offset:768
buffer_load_dwordx4 v[64:67], v9, s[44:47], s10 offen offset:0 nt
buffer_load_dwordx4 v[68:71], v9, s[44:47], s10 offen offset:256 nt
buffer_load_dwordx4 v[72:75], v9, s[44:47], s10 offen offset:512 nt
buffer_load_dwordx4 v[76:79], v9, s[44:47], s10 offen offset:768 nt
buffer_load_dwordx4 v[80:83], v9, s[44:47], s10 offen offset:896 nt
buffer_load_dwordx4 v[84:87], v9, s[44:47], s10 offen offset:1152 nt
buffer_load_dwordx4 v[88:91], v9, s[44:47], s10 offen offset:1408 nt
buffer_load_dwordx4 v[92:95], v9, s[44:47], s10 offen offset:1664 nt
buffer_load_dwordx4 v[96:99], v9, s[44:47], s10 offen offset:1792 nt
buffer_load_dwordx4 v[100:103], v9, s[44:47], s10 offen offset:2048 nt
buffer_load_dwordx4 v[104:107], v9, s[44:47], s10 offen offset:2304 nt
buffer_load_dwordx4 v[108:111], v9, s[44:47], s10 offen offset:2560 nt
buffer_load_dwordx4 v[112:115], v9, s[44:47], s10 offen offset:2688 nt
buffer_load_dwordx4 v[116:119], v9, s[44:47], s10 offen offset:2944 nt
buffer_load_dwordx4 v[120:123], v9, s[44:47], s10 offen offset:3200 nt
buffer_load_dwordx4 v[124:127], v9, s[44:47], s10 offen offset:3456 nt
s_waitcnt vmcnt(16)
v_lshlrev_b32 v24, 16, v24
v_lshlrev_b32 v25, 16, v25
v_lshlrev_b32 v26, 16, v26
v_lshlrev_b32 v27, 16, v27
v_lshlrev_b32 v28, 16, v28
v_lshlrev_b32 v29, 16, v29
v_lshlrev_b32 v30, 16, v30
v_mul_f32 v24, v24, v192
v_mul_f32 v25, v25, v193
v_mul_f32 v26, v26, v194
v_mul_f32 v27, v27, v195
v_mul_f32 v28, v28, v196
v_mul_f32 v29, v29, v197
v_mul_f32 v30, v30, v198
v_cvt_pk_bf16_f32 v24, v24, v24
v_cvt_pk_bf16_f32 v25, v25, v25
v_cvt_pk_bf16_f32 v26, v26, v26
v_cvt_pk_bf16_f32 v27, v27, v27
v_cvt_pk_bf16_f32 v28, v28, v28
v_cvt_pk_bf16_f32 v29, v29, v29
v_cvt_pk_bf16_f32 v30, v30, v30
v_and_b32 v24, 0xffff0000, v24
v_and_b32 v25, 0xffff0000, v25
v_and_b32 v26, 0xffff0000, v26
v_and_b32 v27, 0xffff0000, v27
v_and_b32 v28, 0xffff0000, v28
v_and_b32 v29, 0xffff0000, v29
v_and_b32 v30, 0xffff0000, v30
v_add_f32 v8, v24, v25
v_add_f32 v9, v26, v27
v_add_f32 v10, v28, v29
v_add_f32 v8, v8, v30
v_add_f32 v9, v9, v10
v_add_f32 v8, v8, v9
s_nop 1
v_add_f32_dpp v8, v8, v8 quad_perm:[1,0,3,2] row_mask:0xf bank_mask:0xf
s_nop 1
v_add_f32_dpp v8, v8, v8 quad_perm:[2,3,0,1] row_mask:0xf bank_mask:0xf
s_nop 1
v_add_f32_dpp v8, v8, v8 row_half_mirror row_mask:0xf bank_mask:0xf
s_nop 1
v_add_f32_dpp v8, v8, v8 row_mirror row_mask:0xf bank_mask:0xf
v_mov_b32 v9, v8
s_nop 1
v_permlane16_swap_b32 v9, v8
s_nop 1
v_add_f32 v8, v8, v9
v_mov_b32 v9, v8
s_nop 1
v_permlane32_swap_b32 v9, v8
s_nop 1
v_add_f32 v8, v8, v9
v_cvt_pk_bf16_f32 v8, v8, v8
v_and_b32 v8, 0xffff0000, v8
v_mul_f32 v8, 0x3fb8aa3b, v8
v_sub_f32 v8, 0, v8
v_exp_f32 v8, v8
s_nop 0
v_add_f32 v8, 1.0, v8
v_rcp_f32 v8, v8
s_nop 0
v_cvt_pk_bf16_f32 v8, v8, v8
v_and_b32 v8, 0xffff0000, v8
v_sub_f32 v9, 1.0, v8
v_cvt_pk_bf16_f32 v9, v9, v9
v_and_b32 v9, 0xffff0000, v9
s_nop 0
v_readfirstlane_b32 s72, v8
v_readfirstlane_b32 s73, v9
v_and_b32 v8, 31, v1
v_lshlrev_b32 v8, 3, v8
s_lshl_b32 s13, s4, 8
s_add_u32 s13, s13, 32768
s_mov_b32 s12, 0
L_pollr_a:
buffer_load_dwordx2 v[12:13], v8, s[48:51], s13 offen sc1
s_waitcnt vmcnt(0)
v_cmp_eq_u32 vcc, s66, v12
v_cmp_eq_u32 s[70:71], s67, v13
s_nop 3
s_and_b64 vcc, vcc, s[70:71]
s_cmp_eq_u64 vcc, -1
s_cbranch_scc1 L_svc_join
s_add_u32 s12, s12, 1
s_cmp_lt_u32 s12, 262144
s_cbranch_scc1 L_pollr_a
s_branch L_svc_join
L_svc_b1:
s_cmp_lt_u32 s2, 28
s_cbranch_scc0 L_svc_join
v_lshlrev_b32 v8, 3, v1
s_mov_b32 s13, 32768
s_mov_b32 s12, 0
L_pollr_b:
buffer_load_dwordx2 v[24:25], v8, s[48:51], s13 offen offset:0 sc1
buffer_load_dwordx2 v[26:27], v8, s[48:51], s13 offen offset:512 sc1
buffer_load_dwordx2 v[28:29], v8, s[48:51], s13 offen offset:1024 sc1
buffer_load_dwordx2 v[30:31], v8, s[48:51], s13 offen offset:1536 sc1
s_waitcnt vmcnt(0)
v_cmp_eq_u32 vcc, s66, v24
v_cmp_eq_u32 s[70:71], s67, v25
s_nop 3
s_and_b64 vcc, vcc, s[70:71]
v_cmp_eq_u32 s[70:71], s66, v26
s_nop 3
s_and_b64 vcc, vcc, s[70:71]
v_cmp_eq_u32 s[70:71], s67, v27
s_nop 3
s_and_b64 vcc, vcc, s[70:71]
v_cmp_eq_u32 s[70:71], s66, v28
s_nop 3
s_and_b64 vcc, vcc, s[70:71]
v_cmp_eq_u32 s[70:71], s67, v29
s_nop 3
s_and_b64 vcc, vcc, s[70:71]
v_cmp_eq_u32 s[70:71], s66, v30
s_nop 3
s_and_b64 vcc, vcc, s[70:71]
v_cmp_eq_u32 s[70:71], s67, v31
s_nop 3
s_and_b64 vcc, vcc, s[70:71]
s_cmp_eq_u64 vcc, -1
s_cbranch_scc1 L_svc_join
s_add_u32 s12, s12, 1
s_cmp_lt_u32 s12, 262144
s_cbranch_scc1 L_pollr_b
L_svc_join:
s_waitcnt vmcnt(0) lgkmcnt(0)
s_setprio 3
s_barrier
s_lshl_b32 s42, s3, 10
v_add_u32 v8, s42, v60
s_lshl_b32 s42, s3, 3
v_mov_b32 v9, s42
ds_read_b64 v[144:145], v9 offset:1152
ds_read_b64 v[146:147], v9 offset:1168
ds_read_b64 v[148:149], v9 offset:1184
ds_read_b64 v[150:151], v9 offset:1200
ds_read_b128 v[128:131], v8 offset:8192
ds_read_b128 v[132:135], v8 offset:10240
ds_read_b128 v[136:139], v8 offset:12288
ds_read_b128 v[140:143], v8 offset:14336
s_waitcnt lgkmcnt(4)
v_mov_b32 v10, v144
v_max_f32 v10, v10, v146
v_max_f32 v10, v10, v148
v_max_f32 v10, v10, v150
v_sub_f32 v144, v144, v10
v_sub_f32 v146, v146, v10
v_sub_f32 v148, v148, v10
v_sub_f32 v150, v150, v10
v_exp_f32 v144, v144
v_exp_f32 v146, v146
v_exp_f32 v148, v148
v_exp_f32 v150, v150
s_waitcnt lgkmcnt(0)
v_mul_f32 v11, v144, v145
v_fmac_f32 v11, v146, v147
v_fmac_f32 v11, v148, v149
v_fmac_f32 v11, v150, v151
v_mul_f32 v12, v144, v128
v_mul_f32 v13, v144, v129
v_mul_f32 v14, v144, v130
v_mul_f32 v15, v144, v131
v_fmac_f32 v12, v146, v132
v_fmac_f32 v13, v146, v133
v_fmac_f32 v14, v146, v134
v_fmac_f32 v15, v146, v135
v_fmac_f32 v12, v148, v136
v_fmac_f32 v13, v148, v137
v_fmac_f32 v14, v148, v138
v_fmac_f32 v15, v148, v139
v_fmac_f32 v12, v150, v140
v_fmac_f32 v13, v150, v141
v_fmac_f32 v14, v150, v142
v_fmac_f32 v15, v150, v143
v_min_u32 v10, -2, v10
v_min_u32 v11, -2, v11
v_min_u32 v12, -2, v12
v_min_u32 v13, -2, v13
v_min_u32 v14, -2, v14
v_min_u32 v15, -2, v15
s_mul_i32 s11, s2, 4096
s_add_u32 s11, s11, 65536
s_lshl_b32 s42, s3, 10
s_add_u32 s43, s11, s42
buffer_store_dwordx4 v[12:15], v60, s[48:51], s43 offen sc1
s_lshl_b32 s42, s3, 3
s_add_u32 s43, s11, s42
v_mov_b32 v8, 0
s_mov_b64 exec, 1
buffer_store_dwordx2 v[10:11], v8, s[48:51], s43 offen offset:2048 sc1
s_mov_b64 exec, -1
s_cmp_eq_u32 s3, 0
s_cbranch_scc0 L_svc_b2
v_lshlrev_b32 v8, 12, v3
v_lshl_add_u32 v9, v2, 4, v8
s_lshl_b32 s10, s4, 17
s_add_u32 s10, s10, 65536
s_lshl_b32 s42, s5, 6
s_add_u32 s11, s10, s42
s_add_u32 s14, s11, 65536
s_lshr_b32 s42, s5, 4
s_lshl_b32 s42, s42, 3
s_add_u32 s13, s10, s42
s_add_u32 s13, s13, 2048
s_add_u32 s15, s13, 65536
s_mov_b32 s12, 0
buffer_load_dwordx4 v[216:219], v9, s[48:51], s11 offen sc1
buffer_load_dwordx4 v[220:223], v9, s[48:51], s14 offen sc1
buffer_load_dwordx2 v[224:225], v8, s[48:51], s13 offen sc1
buffer_load_dwordx2 v[226:227], v8, s[48:51], s15 offen sc1
v_lshlrev_b32 v10, 5, v3
v_lshl_add_u32 v10, v2, 3, v10
ds_read_b64 v[140:141], v10 offset:2048
ds_read_b64 v[144:145], v10 offset:2560
ds_read_b64 v[148:149], v10 offset:3072
ds_read_b64 v[152:153], v10 offset:3584
ds_read_b64 v[156:157], v10 offset:4096
ds_read_b64 v[160:161], v10 offset:4608
ds_read_b64 v[164:165], v10 offset:5120
ds_read_b64 v[168:169], v10 offset:5632
s_waitcnt lgkmcnt(0)
v_add_f32 v140, v140, v156
v_add_f32 v141, v141, v157
v_add_f32 v144, v144, v160
v_add_f32 v145, v145, v161
v_add_f32 v148, v148, v164
v_add_f32 v149, v149, v165
v_add_f32 v152, v152, v168
v_add_f32 v153, v153, v169
v_mul_f32 v140, s73, v140
v_mul_f32 v141, s73, v141
v_mul_f32 v144, s73, v144
v_mul_f32 v145, s73, v145
v_mul_f32 v148, s73, v148
v_mul_f32 v149, s73, v149
v_mul_f32 v152, s73, v152
v_mul_f32 v153, s73, v153
L_pollo:
buffer_load_dwordx4 v[228:231], v9, s[48:51], s11 offen sc1
buffer_load_dwordx4 v[232:235], v9, s[48:51], s14 offen sc1
buffer_load_dwordx2 v[236:237], v8, s[48:51], s13 offen sc1
buffer_load_dwordx2 v[238:239], v8, s[48:51], s15 offen sc1
s_waitcnt vmcnt(4)
v_max3_u32 v10, v216, v217, v218
v_max3_u32 v11, v219, v220, v221
v_max3_u32 v12, v222, v223, v224
v_max3_u32 v13, v225, v226, v227
v_max3_u32 v10, v10, v11, v12
v_max_u32 v10, v10, v13
v_cmp_ne_u32 vcc, -1, v10
s_add_u32 s12, s12, 1
s_cmp_eq_u64 vcc, -1
s_cbranch_scc1 L_pollo_d0
buffer_load_dwordx4 v[216:219], v9, s[48:51], s11 offen sc1
buffer_load_dwordx4 v[220:223], v9, s[48:51], s14 offen sc1
buffer_load_dwordx2 v[224:225], v8, s[48:51], s13 offen sc1
buffer_load_dwordx2 v[226:227], v8, s[48:51], s15 offen sc1
s_waitcnt vmcnt(4)
v_max3_u32 v10, v228, v229, v230
v_max3_u32 v11, v231, v232, v233
v_max3_u32 v12, v234, v235, v236
v_max3_u32 v13, v237, v238, v239
v_max3_u32 v10, v10, v11, v12
v_max_u32 v10, v10, v13
v_cmp_ne_u32 vcc, -1, v10
s_add_u32 s12, s12, 1
s_cmp_eq_u64 vcc, -1
s_cbranch_scc1 L_pollo_d1
s_cmp_lt_u32 s12, 262144
s_cbranch_scc1 L_pollo
L_pollo_d1:
v_mov_b32 v128, v228
v_mov_b32 v129, v229
v_mov_b32 v130, v230
v_mov_b32 v131, v231
v_mov_b32 v132, v232
v_mov_b32 v133, v233
v_mov_b32 v134, v234
v_mov_b32 v135, v235
v_mov_b32 v136, v236
v_mov_b32 v137, v237
v_mov_b32 v138, v238
v_mov_b32 v139, v239
s_branch L_pollo_go
L_pollo_d0:
v_mov_b32 v128, v216
v_mov_b32 v129, v217
v_mov_b32 v130, v218
v_mov_b32 v131, v219
v_mov_b32 v132, v220
v_mov_b32 v133, v221
v_mov_b32 v134, v222
v_mov_b32 v135, v223
v_mov_b32 v136, v224
v_mov_b32 v137, v225
v_mov_b32 v138, v226
v_mov_b32 v139, v227
L_pollo_go:
s_mov_b32 s85, s12
v_max_f32 v10, v136, v138
s_nop 1
v_max_f32_dpp v10, v10, v10 quad_perm:[1,0,3,2] row_mask:0xf bank_mask:0xf
s_nop 1
v_max_f32_dpp v10, v10, v10 quad_perm:[2,3,0,1] row_mask:0xf bank_mask:0xf
s_nop 1
v_max_f32_dpp v10, v10, v10 row_half_mirror row_mask:0xf bank_mask:0xf
s_nop 1
v_max_f32_dpp v10, v10, v10 row_mirror row_mask:0xf bank_mask:0xf
s_nop 0
v_sub_f32 v136, v136, v10
v_sub_f32 v138, v138, v10
v_exp_f32 v136, v136
v_exp_f32 v138, v138
s_nop 0
v_mul_f32 v12, v136, v137
v_mul_f32 v128, v136, v128
v_mul_f32 v129, v136, v129
v_mul_f32 v130, v136, v130
v_mul_f32 v131, v136, v131
v_fmac_f32 v12, v138, v139
v_fmac_f32 v128, v138, v132
v_fmac_f32 v129, v138, v133
v_fmac_f32 v130, v138, v134
v_fmac_f32 v131, v138, v135
v_add_f32_dpp v12, v12, v12 quad_perm:[1,0,3,2] row_mask:0xf bank_mask:0xf
v_add_f32_dpp v128, v128, v128 quad_perm:[1,0,3,2] row_mask:0xf bank_mask:0xf
v_add_f32_dpp v129, v129, v129 quad_perm:[1,0,3,2] row_mask:0xf bank_mask:0xf
v_add_f32_dpp v130, v130, v130 quad_perm:[1,0,3,2] row_mask:0xf bank_mask:0xf
v_add_f32_dpp v131, v131, v131 quad_perm:[1,0,3,2] row_mask:0xf bank_mask:0xf
v_add_f32_dpp v12, v12, v12 quad_perm:[2,3,0,1] row_mask:0xf bank_mask:0xf
v_add_f32_dpp v128, v128, v128 quad_perm:[2,3,0,1] row_mask:0xf bank_mask:0xf
v_add_f32_dpp v129, v129, v129 quad_perm:[2,3,0,1] row_mask:0xf bank_mask:0xf
v_add_f32_dpp v130, v130, v130 quad_perm:[2,3,0,1] row_mask:0xf bank_mask:0xf
v_add_f32_dpp v131, v131, v131 quad_perm:[2,3,0,1] row_mask:0xf bank_mask:0xf
v_add_f32_dpp v12, v12, v12 row_half_mirror row_mask:0xf bank_mask:0xf
v_add_f32_dpp v128, v128, v128 row_half_mirror row_mask:0xf bank_mask:0xf
v_add_f32_dpp v129, v129, v129 row_half_mirror row_mask:0xf bank_mask:0xf
v_add_f32_dpp v130, v130, v130 row_half_mirror row_mask:0xf bank_mask:0xf
v_add_f32_dpp v131, v131, v131 row_half_mirror row_mask:0xf bank_mask:0xf
v_add_f32_dpp v12, v12, v12 row_mirror row_mask:0xf bank_mask:0xf
v_add_f32_dpp v128, v128, v128 row_mirror row_mask:0xf bank_mask:0xf
v_add_f32_dpp v129, v129, v129 row_mirror row_mask:0xf bank_mask:0xf
v_add_f32_dpp v130, v130, v130 row_mirror row_mask:0xf bank_mask:0xf
v_add_f32_dpp v131, v131, v131 row_mirror row_mask:0xf bank_mask:0xf
v_rcp_f32 v12, v12
s_nop 0
v_mul_f32 v128, v128, v12
v_mul_f32 v129, v129, v12
v_mul_f32 v130, v130, v12
v_mul_f32 v131, v131, v12
v_cvt_pk_bf16_f32 v128, v128, v128
v_cvt_pk_bf16_f32 v129, v129, v129
v_cvt_pk_bf16_f32 v130, v130, v130
v_cvt_pk_bf16_f32 v131, v131, v131
v_and_b32 v156, v128, v4
v_and_b32 v157, v128, v5
v_and_b32 v158, v128, v6
v_and_b32 v159, v128, v7
v_and_b32 v160, v129, v4
v_and_b32 v161, v129, v5
v_and_b32 v162, v129, v6
v_and_b32 v163, v129, v7
v_mfma_f32_16x16x32_bf16 v[172:175], v[156:159], v[64:67], 0
v_mfma_f32_16x16x32_bf16 v[176:179], v[156:159], v[68:71], 0
v_mfma_f32_16x16x32_bf16 v[180:183], v[156:159], v[72:75], 0
v_mfma_f32_16x16x32_bf16 v[184:187], v[156:159], v[76:79], 0
v_and_b32 v164, v130, v4
v_and_b32 v165, v130, v5
v_and_b32 v166, v130, v6
v_and_b32 v167, v130, v7
v_mfma_f32_16x16x32_bf16 v[172:175], v[160:163], v[80:83], v[172:175]
v_mfma_f32_16x16x32_bf16 v[176:179], v[160:163], v[84:87], v[176:179]
v_mfma_f32_16x16x32_bf16 v[180:183], v[160:163], v[88:91], v[180:183]
v_mfma_f32_16x16x32_bf16 v[184:187], v[160:163], v[92:95], v[184:187]
v_and_b32 v168, v131, v4
v_and_b32 v169, v131, v5
v_and_b32 v170, v131, v6
v_and_b32 v171, v131, v7
v_mfma_f32_16x16x32_bf16 v[172:175], v[164:167], v[96:99], v[172:175]
v_mfma_f32_16x16x32_bf16 v[176:179], v[164:167], v[100:103], v[176:179]
v_mfma_f32_16x16x32_bf16 v[180:183], v[164:167], v[104:107], v[180:183]
v_mfma_f32_16x16x32_bf16 v[184:187], v[164:167], v[108:111], v[184:187]
s_nop 0
v_mfma_f32_16x16x32_bf16 v[172:175], v[168:171], v[112:115], v[172:175]
v_mfma_f32_16x16x32_bf16 v[176:179], v[168:171], v[116:119], v[176:179]
v_mfma_f32_16x16x32_bf16 v[180:183], v[168:171], v[120:123], v[180:183]
v_mfma_f32_16x16x32_bf16 v[184:187], v[168:171], v[124:127], v[184:187]
v_and_b32 v8, 1, v2
v_lshlrev_b32 v8, 9, v8
v_lshl_add_u32 v8, v3, 5, v8
v_lshrrev_b32 v9, 1, v2
v_lshl_add_u32 v8, v9, 4, v8
s_mul_i32 s11, s2, 1792
s_add_u32 s11, s11, 1114112
s_nop 2
v_fma_f32 v128, v172, s72, v140
v_fma_f32 v129, v174, s72, v141
v_fma_f32 v130, v176, s72, v144
v_fma_f32 v131, v178, s72, v145
v_fma_f32 v132, v180, s72, v148
v_fma_f32 v133, v182, s72, v149
v_fma_f32 v134, v184, s72, v152
v_fma_f32 v135, v186, s72, v153
v_min_u32 v128, -2, v128
v_min_u32 v129, -2, v129
v_min_u32 v130, -2, v130
v_min_u32 v131, -2, v131
v_min_u32 v132, -2, v132
v_min_u32 v133, -2, v133
v_min_u32 v134, -2, v134
v_min_u32 v135, -2, v135
s_nop 0
v_permlane16_swap_b32 v128, v130
v_permlane16_swap_b32 v129, v131
v_permlane16_swap_b32 v132, v134
v_permlane16_swap_b32 v133, v135
buffer_store_dwordx4 v[128:131], v8, s[48:51], s11 offen sc1
s_mov_b32 exec_lo, 0x00ffffff
s_mov_b32 exec_hi, 0x00ffffff
buffer_store_dwordx4 v[132:135], v8, s[48:51], s11 offen offset:1024 sc1
s_mov_b64 exec, -1
s_endpgm
L_svc_b2:
s_cmp_lt_u32 s2, 28
s_cbranch_scc0 L_done
v_lshrrev_b32 v8, 2, v1
s_mov_b32 s42, 1792
v_mul_lo_u32 v8, s42, v8
v_and_b32 v9, 3, v1
v_lshl_add_u32 v8, v9, 4, v8
s_lshl_b32 s10, s2, 6
s_add_u32 s10, s10, 1114112
s_mov_b32 s12, 0
s_add_u32 s42, s10, 0
buffer_load_dwordx4 v[64:67], v8, s[48:51], s42 offen sc1
s_add_u32 s42, s10, 28672
buffer_load_dwordx4 v[68:71], v8, s[48:51], s42 offen sc1
s_add_u32 s42, s10, 57344
buffer_load_dwordx4 v[72:75], v8, s[48:51], s42 offen sc1
s_add_u32 s42, s10, 86016
buffer_load_dwordx4 v[76:79], v8, s[48:51], s42 offen sc1
s_add_u32 s42, s10, 114688
buffer_load_dwordx4 v[80:83], v8, s[48:51], s42 offen sc1
s_add_u32 s42, s10, 143360
buffer_load_dwordx4 v[84:87], v8, s[48:51], s42 offen sc1
s_add_u32 s42, s10, 172032
buffer_load_dwordx4 v[88:91], v8, s[48:51], s42 offen sc1
s_add_u32 s42, s10, 200704
buffer_load_dwordx4 v[92:95], v8, s[48:51], s42 offen sc1
s_add_u32 s42, s10, 229376
buffer_load_dwordx4 v[96:99], v8, s[48:51], s42 offen sc1
s_add_u32 s42, s10, 258048
buffer_load_dwordx4 v[100:103], v8, s[48:51], s42 offen sc1
s_add_u32 s42, s10, 286720
buffer_load_dwordx4 v[104:107], v8, s[48:51], s42 offen sc1
s_add_u32 s42, s10, 315392
buffer_load_dwordx4 v[108:111], v8, s[48:51], s42 offen sc1
s_add_u32 s42, s10, 344064
buffer_load_dwordx4 v[112:115], v8, s[48:51], s42 offen sc1
s_add_u32 s42, s10, 372736
buffer_load_dwordx4 v[116:119], v8, s[48:51], s42 offen sc1
s_add_u32 s42, s10, 401408
buffer_load_dwordx4 v[120:123], v8, s[48:51], s42 offen sc1
s_add_u32 s42, s10, 430080
buffer_load_dwordx4 v[124:127], v8, s[48:51], s42 offen sc1
L_pollp:
s_add_u32 s42, s10, 0
buffer_load_dwordx4 v[128:131], v8, s[48:51], s42 offen sc1
s_add_u32 s42, s10, 28672
buffer_load_dwordx4 v[132:135], v8, s[48:51], s42 offen sc1
s_add_u32 s42, s10, 57344
buffer_load_dwordx4 v[136:139], v8, s[48:51], s42 offen sc1
s_add_u32 s42, s10, 86016
buffer_load_dwordx4 v[140:143], v8, s[48:51], s42 offen sc1
s_add_u32 s42, s10, 114688
buffer_load_dwordx4 v[144:147], v8, s[48:51], s42 offen sc1
s_add_u32 s42, s10, 143360
buffer_load_dwordx4 v[148:151], v8, s[48:51], s42 offen sc1
s_add_u32 s42, s10, 172032
buffer_load_dwordx4 v[152:155], v8, s[48:51], s42 offen sc1
s_add_u32 s42, s10, 200704
buffer_load_dwordx4 v[156:159], v8, s[48:51], s42 offen sc1
s_add_u32 s42, s10, 229376
buffer_load_dwordx4 v[160:163], v8, s[48:51], s42 offen sc1
s_add_u32 s42, s10, 258048
buffer_load_dwordx4 v[164:167], v8, s[48:51], s42 offen sc1
s_add_u32 s42, s10, 286720
buffer_load_dwordx4 v[168:171], v8, s[48:51], s42 offen sc1
s_add_u32 s42, s10, 315392
buffer_load_dwordx4 v[172:175], v8, s[48:51], s42 offen sc1
s_add_u32 s42, s10, 344064
buffer_load_dwordx4 v[176:179], v8, s[48:51], s42 offen sc1
s_add_u32 s42, s10, 372736
buffer_load_dwordx4 v[180:183], v8, s[48:51], s42 offen sc1
s_add_u32 s42, s10, 401408
buffer_load_dwordx4 v[184:187], v8, s[48:51], s42 offen sc1
s_add_u32 s42, s10, 430080
buffer_load_dwordx4 v[188:191], v8, s[48:51], s42 offen sc1
s_waitcnt vmcnt(16)
v_pk_add_f32 v[192:193], v[64:65], v[96:97]
v_pk_add_f32 v[194:195], v[66:67], v[98:99]
v_pk_add_f32 v[196:197], v[68:69], v[100:101]
v_pk_add_f32 v[198:199], v[70:71], v[102:103]
v_pk_add_f32 v[200:201], v[72:73], v[104:105]
v_pk_add_f32 v[202:203], v[74:75], v[106:107]
v_pk_add_f32 v[204:205], v[76:77], v[108:109]
v_pk_add_f32 v[206:207], v[78:79], v[110:111]
v_pk_add_f32 v[208:209], v[80:81], v[112:113]
v_pk_add_f32 v[210:211], v[82:83], v[114:115]
v_pk_add_f32 v[212:213], v[84:85], v[116:117]
v_pk_add_f32 v[214:215], v[86:87], v[118:119]
v_pk_add_f32 v[216:217], v[88:89], v[120:121]
v_pk_add_f32 v[218:219], v[90:91], v[122:123]
v_pk_add_f32 v[220:221], v[92:93], v[124:125]
v_pk_add_f32 v[222:223], v[94:95], v[126:127]
v_pk_add_f32 v[192:193], v[192:193], v[208:209]
v_pk_add_f32 v[194:195], v[194:195], v[210:211]
v_pk_add_f32 v[196:197], v[196:197], v[212:213]
v_pk_add_f32 v[198:199], v[198:199], v[214:215]
v_pk_add_f32 v[200:201], v[200:201], v[216:217]
v_pk_add_f32 v[202:203], v[202:203], v[218:219]
v_pk_add_f32 v[204:205], v[204:205], v[220:221]
v_pk_add_f32 v[206:207], v[206:207], v[222:223]
v_pk_add_f32 v[192:193], v[192:193], v[200:201]
v_pk_add_f32 v[194:195], v[194:195], v[202:203]
v_pk_add_f32 v[196:197], v[196:197], v[204:205]
v_pk_add_f32 v[198:199], v[198:199], v[206:207]
v_pk_add_f32 v[192:193], v[192:193], v[196:197]
v_pk_add_f32 v[194:195], v[194:195], v[198:199]
v_cmp_u_f32 vcc, v192, v193
v_cmp_u_f32 s[70:71], v194, v195
s_add_u32 s12, s12, 1
s_nop 1
s_or_b64 vcc, vcc, s[70:71]
s_cmp_eq_u64 vcc, 0
s_cbranch_scc1 L_pollp_done
v_max3_u32 v10, v64, v65, v66
v_max3_u32 v10, v10, v67, v68
v_max3_u32 v10, v10, v69, v70
v_max3_u32 v10, v10, v71, v72
v_max3_u32 v10, v10, v73, v74
v_max3_u32 v10, v10, v75, v76
v_max3_u32 v10, v10, v77, v78
v_max3_u32 v10, v10, v79, v80
v_max3_u32 v10, v10, v81, v82
v_max3_u32 v10, v10, v83, v84
v_max3_u32 v10, v10, v85, v86
v_max3_u32 v10, v10, v87, v88
v_max3_u32 v10, v10, v89, v90
v_max3_u32 v10, v10, v91, v92
v_max3_u32 v10, v10, v93, v94
v_max3_u32 v10, v10, v95, v96
v_max3_u32 v10, v10, v97, v98
v_max3_u32 v10, v10, v99, v100
v_max3_u32 v10, v10, v101, v102
v_max3_u32 v10, v10, v103, v104
v_max3_u32 v10, v10, v105, v106
v_max3_u32 v10, v10, v107, v108
v_max3_u32 v10, v10, v109, v110
v_max3_u32 v10, v10, v111, v112
v_max3_u32 v10, v10, v113, v114
v_max3_u32 v10, v10, v115, v116
v_max3_u32 v10, v10, v117, v118
v_max3_u32 v10, v10, v119, v120
v_max3_u32 v10, v10, v121, v122
v_max3_u32 v10, v10, v123, v124
v_max3_u32 v10, v10, v125, v126
v_max_u32 v10, v10, v127
v_cmp_ne_u32 vcc, -1, v10
s_nop 1
s_cmp_eq_u64 vcc, -1
s_cbranch_scc1 L_pollp_done
s_add_u32 s42, s10, 0
buffer_load_dwordx4 v[64:67], v8, s[48:51], s42 offen sc1
s_add_u32 s42, s10, 28672
buffer_load_dwordx4 v[68:71], v8, s[48:51], s42 offen sc1
s_add_u32 s42, s10, 57344
buffer_load_dwordx4 v[72:75], v8, s[48:51], s42 offen sc1
s_add_u32 s42, s10, 86016
buffer_load_dwordx4 v[76:79], v8, s[48:51], s42 offen sc1
s_add_u32 s42, s10, 114688
buffer_load_dwordx4 v[80:83], v8, s[48:51], s42 offen sc1
s_add_u32 s42, s10, 143360
buffer_load_dwordx4 v[84:87], v8, s[48:51], s42 offen sc1
s_add_u32 s42, s10, 172032
buffer_load_dwordx4 v[88:91], v8, s[48:51], s42 offen sc1
s_add_u32 s42, s10, 200704
buffer_load_dwordx4 v[92:95], v8, s[48:51], s42 offen sc1
s_add_u32 s42, s10, 229376
buffer_load_dwordx4 v[96:99], v8, s[48:51], s42 offen sc1
s_add_u32 s42, s10, 258048
buffer_load_dwordx4 v[100:103], v8, s[48:51], s42 offen sc1
s_add_u32 s42, s10, 286720
buffer_load_dwordx4 v[104:107], v8, s[48:51], s42 offen sc1
s_add_u32 s42, s10, 315392
buffer_load_dwordx4 v[108:111], v8, s[48:51], s42 offen sc1
s_add_u32 s42, s10, 344064
buffer_load_dwordx4 v[112:115], v8, s[48:51], s42 offen sc1
s_add_u32 s42, s10, 372736
buffer_load_dwordx4 v[116:119], v8, s[48:51], s42 offen sc1
s_add_u32 s42, s10, 401408
buffer_load_dwordx4 v[120:123], v8, s[48:51], s42 offen sc1
s_add_u32 s42, s10, 430080
buffer_load_dwordx4 v[124:127], v8, s[48:51], s42 offen sc1
s_waitcnt vmcnt(16)
v_pk_add_f32 v[192:193], v[128:129], v[160:161]
v_pk_add_f32 v[194:195], v[130:131], v[162:163]
v_pk_add_f32 v[196:197], v[132:133], v[164:165]
v_pk_add_f32 v[198:199], v[134:135], v[166:167]
v_pk_add_f32 v[200:201], v[136:137], v[168:169]
v_pk_add_f32 v[202:203], v[138:139], v[170:171]
v_pk_add_f32 v[204:205], v[140:141], v[172:173]
v_pk_add_f32 v[206:207], v[142:143], v[174:175]
v_pk_add_f32 v[208:209], v[144:145], v[176:177]
v_pk_add_f32 v[210:211], v[146:147], v[178:179]
v_pk_add_f32 v[212:213], v[148:149], v[180:181]
v_pk_add_f32 v[214:215], v[150:151], v[182:183]
v_pk_add_f32 v[216:217], v[152:153], v[184:185]
v_pk_add_f32 v[218:219], v[154:155], v[186:187]
v_pk_add_f32 v[220:221], v[156:157], v[188:189]
v_pk_add_f32 v[222:223], v[158:159], v[190:191]
v_pk_add_f32 v[192:193], v[192:193], v[208:209]
v_pk_add_f32 v[194:195], v[194:195], v[210:211]
v_pk_add_f32 v[196:197], v[196:197], v[212:213]
v_pk_add_f32 v[198:199], v[198:199], v[214:215]
v_pk_add_f32 v[200:201], v[200:201], v[216:217]
v_pk_add_f32 v[202:203], v[202:203], v[218:219]
v_pk_add_f32 v[204:205], v[204:205], v[220:221]
v_pk_add_f32 v[206:207], v[206:207], v[222:223]
v_pk_add_f32 v[192:193], v[192:193], v[200:201]
v_pk_add_f32 v[194:195], v[194:195], v[202:203]
v_pk_add_f32 v[196:197], v[196:197], v[204:205]
v_pk_add_f32 v[198:199], v[198:199], v[206:207]
v_pk_add_f32 v[192:193], v[192:193], v[196:197]
v_pk_add_f32 v[194:195], v[194:195], v[198:199]
v_cmp_u_f32 vcc, v192, v193
v_cmp_u_f32 s[70:71], v194, v195
s_add_u32 s12, s12, 1
s_nop 1
s_or_b64 vcc, vcc, s[70:71]
s_cmp_eq_u64 vcc, 0
s_cbranch_scc1 L_pollp_done
v_max3_u32 v10, v128, v129, v130
v_max3_u32 v10, v10, v131, v132
v_max3_u32 v10, v10, v133, v134
v_max3_u32 v10, v10, v135, v136
v_max3_u32 v10, v10, v137, v138
v_max3_u32 v10, v10, v139, v140
v_max3_u32 v10, v10, v141, v142
v_max3_u32 v10, v10, v143, v144
v_max3_u32 v10, v10, v145, v146
v_max3_u32 v10, v10, v147, v148
v_max3_u32 v10, v10, v149, v150
v_max3_u32 v10, v10, v151, v152
v_max3_u32 v10, v10, v153, v154
v_max3_u32 v10, v10, v155, v156
v_max3_u32 v10, v10, v157, v158
v_max3_u32 v10, v10, v159, v160
v_max3_u32 v10, v10, v161, v162
v_max3_u32 v10, v10, v163, v164
v_max3_u32 v10, v10, v165, v166
v_max3_u32 v10, v10, v167, v168
v_max3_u32 v10, v10, v169, v170
v_max3_u32 v10, v10, v171, v172
v_max3_u32 v10, v10, v173, v174
v_max3_u32 v10, v10, v175, v176
v_max3_u32 v10, v10, v177, v178
v_max3_u32 v10, v10, v179, v180
v_max3_u32 v10, v10, v181, v182
v_max3_u32 v10, v10, v183, v184
v_max3_u32 v10, v10, v185, v186
v_max3_u32 v10, v10, v187, v188
v_max3_u32 v10, v10, v189, v190
v_max_u32 v10, v10, v191
v_cmp_ne_u32 vcc, -1, v10
s_nop 1
s_cmp_eq_u64 vcc, -1
s_cbranch_scc1 L_pollp_done
s_cmp_lt_u32 s12, 262144
s_cbranch_scc1 L_pollp
L_pollp_done:
s_mov_b32 s85, s12
s_nop 1
v_add_f32_dpp v192, v192, v192 row_ror:4 row_mask:0xf bank_mask:0xf
v_add_f32_dpp v193, v193, v193 row_ror:4 row_mask:0xf bank_mask:0xf
v_add_f32_dpp v194, v194, v194 row_ror:4 row_mask:0xf bank_mask:0xf
v_add_f32_dpp v195, v195, v195 row_ror:4 row_mask:0xf bank_mask:0xf
s_nop 1
v_add_f32_dpp v192, v192, v192 row_ror:8 row_mask:0xf bank_mask:0xf
v_add_f32_dpp v193, v193, v193 row_ror:8 row_mask:0xf bank_mask:0xf
v_add_f32_dpp v194, v194, v194 row_ror:8 row_mask:0xf bank_mask:0xf
v_add_f32_dpp v195, v195, v195 row_ror:8 row_mask:0xf bank_mask:0xf
v_mov_b32 v196, v192
v_mov_b32 v197, v193
v_mov_b32 v198, v194
v_mov_b32 v199, v195
s_nop 1
v_permlane16_swap_b32 v196, v192
v_permlane16_swap_b32 v197, v193
v_permlane16_swap_b32 v198, v194
v_permlane16_swap_b32 v199, v195
s_nop 1
v_add_f32 v192, v192, v196
v_add_f32 v193, v193, v197
v_add_f32 v194, v194, v198
v_add_f32 v195, v195, v199
v_mov_b32 v196, v192
v_mov_b32 v197, v193
v_mov_b32 v198, v194
v_mov_b32 v199, v195
s_nop 1
v_permlane32_swap_b32 v196, v192
v_permlane32_swap_b32 v197, v193
v_permlane32_swap_b32 v198, v194
v_permlane32_swap_b32 v199, v195
s_nop 1
v_add_f32 v192, v192, v196
v_add_f32 v193, v193, v197
v_add_f32 v194, v194, v198
v_add_f32 v195, v195, v199
v_cvt_pk_bf16_f32 v10, v192, v193
v_cvt_pk_bf16_f32 v11, v194, v195
s_mov_b32 s44, s36
s_mov_b32 s45, s37
s_mov_b32 s46, 896
s_mov_b32 s47, 0x20000
s_lshl_b32 s42, s2, 5
v_lshlrev_b32 v8, 3, v1
s_mov_b64 exec, 15
buffer_store_dwordx2 v[10:11], v8, s[44:47], s42 offen
s_mov_b64 exec, -1
s_cmp_eq_u32 s2, 0
s_cbranch_scc0 L_fin
s_sub_u32 s42, s66, 2654435761
s_subb_u32 s43, s67, 2135587861
s_add_u32 s42, s42, 1
s_addc_u32 s43, s43, 0
v_mov_b32 v10, s42
v_mov_b32 v11, s43
v_mov_b32 v8, 0
s_mov_b64 exec, 1
buffer_store_dwordx2 v[10:11], v8, s[48:51], 0 offen offset:0 sc1
s_mov_b64 exec, -1
L_fin:
L_done:
s_endpgm
.section .rodata,"a"
.p2align 6
.amdhsa_kernel gated_mix__gqa_block_cached__glu_gated_reglu__decode_kernel
.amdhsa_next_free_vgpr 256
.amdhsa_next_free_sgpr 102
.amdhsa_accum_offset 256
.amdhsa_group_segment_fixed_size 0
.amdhsa_kernarg_size 104
.amdhsa_user_sgpr_count 2
.amdhsa_user_sgpr_kernarg_segment_ptr 1
.amdhsa_system_sgpr_workgroup_id_x 1
.end_amdhsa_kernel
```
